```python
import torch

def _softmax(x, axis=-1):
    return torch.softmax(x, dim=axis)
def _gelu(x):
    return torch.nn.functional.gelu(x, approximate="tanh")
def _silu(x):
    return torch.nn.functional.silu(x)
def _sigmoid(x):
    return torch.sigmoid(x)
def _layernorm(x, axis=-1, eps=1e-5):
    m = x.mean(dim=axis, keepdim=True)
    v = x.var(dim=axis, keepdim=True, unbiased=False)
    return (x - m) / torch.sqrt(v + eps)
def _scatter_add(tgt, idx, src, axis=0):
    return tgt.clone().index_add_(axis, idx, src)
def _segment_sum(src, seg, n):
    out = torch.zeros((n,) + src.shape[1:], dtype=src.dtype)
    return out.index_add_(0, seg, src)
def _pad(x, pw):
    flat = tuple(v for pair in reversed(pw) for v in pair)
    return torch.nn.functional.pad(x, flat)

kernel_name = 'recurrent_scan__mha_block__glu_gated_glu__prompt'

def setup_inputs():

    _w = (lambda a: (lambda t: t.to(torch.bfloat16) if t.is_floating_point() else t)(torch.as_tensor(a)))
    def _A_setup():
        B, S, D, H = 1, 2048, 512, 32
        return {
            "x": _w((lambda *s: torch.randn(*s, dtype=torch.bfloat16) * 0.05)(B, S, D)),
            "wqkv": _w((lambda *s: torch.randn(*s, dtype=torch.bfloat16) * 0.05)(D, 3 * D)),
            "wo": _w((lambda *s: torch.randn(*s, dtype=torch.bfloat16) * 0.05)(D, D)),
        }
    _A_in = _A_setup()

    def _B_setup():
        B, S, D, F = 1, 2048, 512, 1792
        return {
            "x": _w((lambda *s: torch.randn(*s, dtype=torch.bfloat16) * 0.05)(B, S, D)),
            "w_gate": _w((lambda *s: torch.randn(*s, dtype=torch.bfloat16) * 0.05)(D, F)),
            "w_up": _w((lambda *s: torch.randn(*s, dtype=torch.bfloat16) * 0.05)(D, F)),
            "w_down": _w((lambda *s: torch.randn(*s, dtype=torch.bfloat16) * 0.05)(F, D)),
        }
    _B_in = _B_setup()

    return {
        "A_x": _A_in["x"],
        "A_wqkv": _A_in["wqkv"],
        "A_wo": _A_in["wo"],
        "B_x": _B_in["x"],
        "B_w_gate": _B_in["w_gate"],
        "B_w_up": _B_in["w_up"],
        "B_w_down": _B_in["w_down"],
    }

def reference(A_x, A_wqkv, A_wo, B_x, B_w_gate, B_w_up, B_w_down):
    def _A_ref(x, wqkv, wo):
        B, S, D = x.shape
        H = 32
        Dh = D // H
        qkv = (lambda x, *d: x.permute(*d))((x @ wqkv).reshape(B, S, 3, H, Dh), 2, 0, 3, 1, 4)
        q, k, v = qkv[0], qkv[1], qkv[2]
        scores = torch.einsum("bhqd,bhkd->bhqk", q, k) * (Dh ** -0.5)
        p = _softmax(scores, axis=-1)
        o = torch.einsum("bhqk,bhkd->bhqd", p, v)
        return (lambda x, *d: x.permute(*d))(o, 0, 2, 1, 3).reshape(B, S, D) @ wo

    def _B_ref(x, w_gate, w_up, w_down):
        g = torch.einsum("bsd,df->bsf", x, w_gate)
        u = torch.einsum("bsd,df->bsf", x, w_up)
        h = _sigmoid(g) * u
        return torch.einsum("bsf,fd->bsd", h, w_down)

    x = A_x
    xn = _layernorm(x, axis=-1)
    s = _A_ref(xn, A_wqkv, A_wo)
    g = _silu(_B_ref(xn, B_w_gate, B_w_up, B_w_down))
    return x + s * g
```

```asm
; @launch grid=(256,1,1) block=(512,1,1) lds=163840
.amdgcn_target "amdgcn-amd-amdhsa--gfx950"
.text
.globl recurrent_scan__mha_block__glu_gated_glu__prompt_kernel
.p2align 8
.type recurrent_scan__mha_block__glu_gated_glu__prompt_kernel,@function
recurrent_scan__mha_block__glu_gated_glu__prompt_kernel:
    s_cmp_ge_u32 s2, 256
    s_cbranch_scc1 K1_EXIT
    s_load_dwordx16 s[4:19], s[0:1], 0
    s_load_dwordx4 s[20:23], s[0:1], 64
    s_memrealtime s[38:39]
    s_getpc_b64 s[66:67]
G_PC:
    s_lshr_b32 s37, s2, 3
    s_lshl_b32 s37, s37, 13
    v_lshl_add_u32 v3, v0, 4, s37
    v_cmp_gt_u32 vcc, G_CODE_END-G_PC-16, v3
    s_and_saveexec_b64 s[68:69], vcc
    s_cbranch_execz G_NOCPF
    global_load_dwordx4 v[240:243], v3, s[66:67]
G_NOCPF:
    s_mov_b64 exec, -1
    v_lshrrev_b32 v2, 6, v0
    v_and_b32 v1, 63, v0
    v_readfirstlane_b32 s48, v2
    s_and_b32 s51, s2, 7
    s_lshr_b32 s52, s2, 3
    s_and_b32 s49, s51, 1
    s_lshl_b32 s49, s49, 2
    s_and_b32 s53, s52, 3
    s_add_u32 s49, s49, s53
    s_lshr_b32 s51, s51, 1
    s_lshr_b32 s52, s52, 2
    s_lshl_b32 s50, s51, 3
    s_add_u32 s50, s50, s52
    s_lshl_b32 s53, s51, 2
    s_and_b32 s55, s52, 3
    s_add_u32 s53, s53, s55
    s_lshl_b32 s54, s49, 3
    s_add_u32 s54, s54, s48
    s_lshl_b32 s36, s50, 3
    s_add_u32 s36, s36, s49
    s_lshl_b32 s36, s36, 7
    s_add_u32 s36, s36, 23068672
    v_lshlrev_b32 v11, 2, v1
    v_lshrrev_b32 v24, 3, v1
    v_and_b32 v25, 7, v1
    v_lshrrev_b32 v26, 4, v1
    s_lshl_b32 s55, s54, 15
    v_xor_b32 v27, v26, v25
    v_lshlrev_b32 v27, 4, v27
    v_lshl_add_u32 v27, v24, 10, v27
    v_add_u32 v4, s55, v27
    v_xor_b32 v5, 64, v4
    v_add_u32 v6, 14336, v4
    v_add_u32 v7, 21504, v5
    v_add_u32 v5, 7168, v5
    s_lshl_b32 s60, s48, 12
    s_lshl_b32 s61, s48, 10
    s_add_u32 s61, s61, 32768
    s_mov_b32 m0, s60
    s_and_b32 s3, s49, 3
    s_lshl_b32 s3, s3, 1
    s_lshr_b32 s37, s49, 2
    s_add_u32 s3, s3, s37
    s_mul_i32 s37, s52, 2
    s_add_u32 s3, s3, s37
    s_and_b32 s3, s3, 7
    s_lshl_b32 s64, s3, 7
    s_waitcnt lgkmcnt(0)
    s_mov_b32 s24, s4
    s_mov_b32 s25, s5
    s_mov_b32 s26, 0x200000
    s_mov_b32 s27, 0x00020000
    s_lshl_b32 s55, s49, 5
    s_add_u32 s55, s55, s50
    s_lshl_b32 s55, s55, 3
    s_add_u32 s55, s55, s48
    s_lshl_b32 s55, s55, 10
    v_lshlrev_b32 v2, 4, v1
    buffer_load_dwordx4 v[224:227], v2, s[24:27], s55 offen
    buffer_load_dwordx4 v4, s[24:27], s64 offen offset:0 lds
    buffer_load_dwordx4 v5, s[24:27], s64 offen offset:1024 lds
    buffer_load_dwordx4 v6, s[24:27], s64 offen offset:2048 lds
    buffer_load_dwordx4 v7, s[24:27], s64 offen offset:3072 lds
    s_mov_b32 s40, s22
    s_mov_b32 s41, s23
    s_mov_b32 s42, 0x1800000
    s_mov_b32 s43, 0x00020000
    s_mov_b32 s44, s20
    s_mov_b32 s45, s21
    s_mov_b32 s46, 0x100
    s_mov_b32 s47, 0x00020000
    s_or_b32 s37, s2, s48
    s_cmp_lg_u32 s37, 0
    s_cbranch_scc1 G_NONONCE
    s_lshl_b32 s37, s38, 3
    s_or_b32 s37, s37, 1
    v_mov_b32 v0, s37
    s_mov_b64 exec, 1
    buffer_store_dword v0, off, s[44:47], 0 sc1
    s_mov_b64 exec, -1
G_NONONCE:
    s_cmp_lt_u32 s52, 4
    s_cbranch_scc1 G_TYPEB
    s_lshl_b32 s55, s48, 3
    v_add_u32 v26, s55, v24
    v_bfe_u32 v27, v1, 4, 1
    s_mov_b32 s58, 3584
    v_mul_lo_u32 v26, v26, s58
    s_mov_b32 s28, s12
    s_mov_b32 s29, s13
    s_mov_b32 s30, 0x1c0000
    s_mov_b32 s31, 0x00020000
    s_mov_b32 s32, s14
    s_mov_b32 s33, s15
    s_mov_b32 s34, 0x1c0000
    s_mov_b32 s35, 0x00020000
    s_lshl_b32 s56, s53, 7
    v_lshlrev_b32 v27, 1, v27
    v_xor_b32 v27, v27, v25
    v_xor_b32 v25, 4, v27
    v_lshl_add_u32 v8, v27, 4, v26
    v_add_u32 v8, s56, v8
    v_lshl_add_u32 v9, v25, 4, v26
    v_add_u32 v9, s56, v9
    s_add_u32 s62, s61, 8192
    v_lshrrev_b32 v26, 4, v1
    v_and_b32 v27, 15, v1
    v_lshlrev_b32 v27, 4, v27
    v_lshl_add_u32 v246, v26, 10, v27
    s_lshl_b32 s70, s49, 3
    s_add_u32 s70, s70, s52
    s_lshl_b32 s70, s70, 3
    s_add_u32 s70, s70, s48
    s_lshl_b32 s70, s70, 12
    s_and_b32 s71, s49, 3
    s_lshl_b32 s71, s71, 5
    s_bitcmp1_b32 s48, 2
    s_cselect_b32 s72, s14, s12
    s_cselect_b32 s73, s15, s13
    s_mov_b32 s74, 0x1c0000
    s_mov_b32 s75, 0x00020000
    s_and_b32 s57, s48, 3
    s_lshl_b32 s57, s57, 3
    s_add_u32 s71, s71, s57
    v_mul_lo_u32 v26, v24, s58
    v_and_b32 v27, 7, v1
    v_lshl_add_u32 v247, v27, 4, v26
    s_mul_i32 s71, s71, s58
    s_lshl_b32 s57, s53, 7
    s_add_u32 s71, s71, s57
    s_add_u32 s65, s3, 0
    s_and_b32 s65, s65, 7
    s_lshl_b32 s67, s65, 7
    s_mul_i32 s65, s65, 229376
    s_add_u32 m0, s61, 0
    s_nop 0
    buffer_load_dwordx4 v8, s[28:31], s65 offen lds
    s_add_u32 m0, s62, 0
    s_nop 0
    buffer_load_dwordx4 v9, s[32:35], s65 offen lds
    s_mov_b32 s66, 3584
    s_lshr_b32 s55, s48, 2
    s_cmp_eq_u32 s55, 0
    s_cselect_b32 s72, s12, s14
    s_cselect_b32 s73, s13, s15
    s_mov_b32 s74, 0x1c0000
    s_mov_b32 s75, 0x00020000
    s_and_b32 s56, s48, 3
    s_lshl_b32 s57, s3, 2
    s_add_u32 s57, s57, s56
    s_mul_i32 s57, s57, 57344
    s_lshl_b32 s55, s48, 10
    s_add_u32 m0, s55, 147456
    v_bfe_u32 v26, v1, 1, 4
    v_mul_lo_u32 v26, v26, s66
    v_and_b32 v27, 1, v1
    v_lshl_add_u32 v26, v27, 4, v26
    s_add_u32 s70, s53, 96
    s_lshl_b32 s70, s70, 5
    s_add_u32 s57, s57, s70
    s_mov_b32 exec_hi, 0
    buffer_load_dwordx4 v26, s[72:75], s57 offen lds
    s_mov_b32 exec_hi, -1
    v_lshrrev_b32 v23, 2, v1
    v_lshlrev_b32 v23, 5, v23
    v_and_b32 v27, 3, v1
    v_lshl_add_u32 v23, v27, 3, v23
    s_add_u32 s55, s55, 147456
    v_add_u32 v23, s55, v23
    v_and_b32 v24, 31, v1
    v_lshrrev_b32 v25, 5, v1
    v_lshlrev_b32 v2, 4, v1
    v_bfe_u32 v26, v1, 1, 3
    v_xor_b32 v26, v26, v25
    v_lshlrev_b32 v27, 7, v24
    v_add_u32 v27, s60, v27
    v_xor_b32 v28, 0, v26
    v_lshl_add_u32 v12, v28, 4, v27
    v_xor_b32 v28, 2, v26
    v_lshl_add_u32 v13, v28, 4, v27
    v_xor_b32 v28, 4, v26
    v_lshl_add_u32 v14, v28, 4, v27
    v_xor_b32 v28, 6, v26
    v_lshl_add_u32 v15, v28, 4, v27
    v_bfe_u32 v24, v1, 4, 1
    v_bfe_u32 v26, v1, 2, 2
    v_and_b32 v27, 3, v1
    v_bfe_u32 v28, v1, 3, 1
    v_lshl_add_u32 v29, v25, 3, v26
    v_lshlrev_b32 v3, 7, v29
    v_lshl_add_u32 v3, v27, 3, v3
    v_lshl_add_u32 v3, v24, 13, v3
    v_add_u32 v3, 32768, v3
    v_lshl_or_b32 v10, v24, 1, v28
    v_xor_b32 v31, 0, v10
    v_lshl_add_u32 v16, v31, 5, v3
    v_xor_b32 v31, 1, v10
    v_lshl_add_u32 v17, v31, 5, v3
    v_xor_b32 v31, 2, v10
    v_lshl_add_u32 v18, v31, 5, v3
    v_xor_b32 v31, 3, v10
    v_lshl_add_u32 v19, v31, 5, v3
    v_lshlrev_b32 v3, 7, v26
    v_lshl_add_u32 v3, v27, 3, v3
    v_add_u32 v3, s61, v3
    v_lshl_add_u32 v3, v24, 13, v3
    v_xor_b32 v10, v10, v25
    v_lshl_add_u32 v30, v10, 5, v3
    v_xor_b32 v31, 64, v30
    v_mov_b32 v20, 0
    v_mov_b32 v28, 0
    v_mov_b32 v29, 0
    s_mov_b32 s68, 0x3f803f80
    s_mov_b32 s69, 0xffff0000
    s_mov_b32 s58, 3584
    v_lshrrev_b32 v26, 1, v1
    s_add_u32 s55, s48, s3
    s_and_b32 s55, s55, 7
    s_lshl_b32 s55, s55, 6
    v_add_u32 v26, s55, v26
    v_xor_b32 v27, 4, v26
    v_mul_lo_u32 v24, v26, s58
    v_mul_lo_u32 v25, v27, s58
    v_and_b32 v26, 1, v1
    v_lshlrev_b32 v26, 4, v26
    s_add_u32 s55, s53, 96
    s_lshl_b32 s55, s55, 5
    v_add_u32 v26, s55, v26
    v_add_u32 v24, v24, v26
    v_add_u32 v25, v25, v26
    s_lshl_b32 s63, s48, 11
    s_waitcnt vmcnt(7)
    v_lshlrev_b32 v228, 16, v224
    v_and_b32 v229, s69, v224
    v_lshlrev_b32 v230, 16, v225
    v_and_b32 v231, s69, v225
    v_lshlrev_b32 v232, 16, v226
    v_and_b32 v233, s69, v226
    v_lshlrev_b32 v234, 16, v227
    v_and_b32 v235, s69, v227
    v_add_f32 v236, v228, v229
    v_add_f32 v237, v230, v231
    v_add_f32 v238, v232, v233
    v_add_f32 v239, v234, v235
    v_add_f32 v236, v236, v237
    v_add_f32 v238, v238, v239
    v_add_f32 v236, v236, v238
    s_nop 1
    v_add_f32_dpp v236, v236, v236 quad_perm:[1,0,3,2] row_mask:0xf bank_mask:0xf
    s_nop 1
    v_add_f32_dpp v236, v236, v236 quad_perm:[2,3,0,1] row_mask:0xf bank_mask:0xf
    s_nop 1
    v_add_f32_dpp v236, v236, v236 row_half_mirror row_mask:0xf bank_mask:0xf
    s_nop 1
    v_add_f32_dpp v236, v236, v236 row_mirror row_mask:0xf bank_mask:0xf
    v_mov_b32 v237, v236
    s_nop 1
    v_permlane16_swap_b32 v236, v237
    s_nop 1
    v_add_f32 v236, v236, v237
    v_mov_b32 v237, v236
    s_nop 1
    v_permlane32_swap_b32 v236, v237
    s_nop 1
    v_add_f32 v236, v236, v237
    v_mul_f32 v236, 0xbb000000, v236
    v_add_f32 v228, v228, v236
    v_add_f32 v229, v229, v236
    v_add_f32 v230, v230, v236
    v_add_f32 v231, v231, v236
    v_add_f32 v232, v232, v236
    v_add_f32 v233, v233, v236
    v_add_f32 v234, v234, v236
    v_add_f32 v235, v235, v236
    v_mul_f32 v238, v228, v228
    v_mul_f32 v239, v229, v229
    v_fmac_f32 v238, v230, v230
    v_fmac_f32 v239, v231, v231
    v_fmac_f32 v238, v232, v232
    v_fmac_f32 v239, v233, v233
    v_fmac_f32 v238, v234, v234
    v_fmac_f32 v239, v235, v235
    v_add_f32 v238, v238, v239
    s_nop 1
    v_add_f32_dpp v238, v238, v238 quad_perm:[1,0,3,2] row_mask:0xf bank_mask:0xf
    s_nop 1
    v_add_f32_dpp v238, v238, v238 quad_perm:[2,3,0,1] row_mask:0xf bank_mask:0xf
    s_nop 1
    v_add_f32_dpp v238, v238, v238 row_half_mirror row_mask:0xf bank_mask:0xf
    s_nop 1
    v_add_f32_dpp v238, v238, v238 row_mirror row_mask:0xf bank_mask:0xf
    v_mov_b32 v237, v238
    s_nop 1
    v_permlane16_swap_b32 v238, v237
    s_nop 1
    v_add_f32 v238, v238, v237
    v_mov_b32 v237, v238
    s_nop 1
    v_permlane32_swap_b32 v238, v237
    s_nop 1
    v_add_f32 v238, v238, v237
    v_mul_f32 v238, 0x3b000000, v238
    v_cvt_pk_bf16_f32 v238, v238, v238
    v_and_b32 v238, s69, v238
    v_add_f32 v238, 0x3727c5ac, v238
    v_cvt_pk_bf16_f32 v238, v238, v238
    v_and_b32 v238, s69, v238
    v_sqrt_f32 v238, v238
    v_cvt_pk_bf16_f32 v236, v236, v236
    v_cvt_pk_bf16_f32 v238, v238, v238
    v_and_b32 v238, s69, v238
    v_rcp_f32 v237, v238
    s_lshl_b32 s55, s48, 3
    s_add_u32 s55, s55, 161408
    v_mov_b32 v239, s55
    ds_write_b64 v239, v[236:237]
    s_add_u32 s65, s3, 1
    s_and_b32 s65, s65, 7
    s_lshl_b32 s67, s65, 7
    s_mul_i32 s65, s65, 229376
    s_add_u32 m0, s61, 49152
    s_nop 0
    buffer_load_dwordx4 v8, s[28:31], s65 offen lds
    s_add_u32 m0, s62, 49152
    s_nop 0
    buffer_load_dwordx4 v9, s[32:35], s65 offen lds
    s_add_u32 m0, s60, 49152
    s_mov_b32 s64, s67
    buffer_load_dwordx4 v4, s[24:27], s64 offen offset:0 lds
    buffer_load_dwordx4 v5, s[24:27], s64 offen offset:1024 lds
    buffer_load_dwordx4 v6, s[24:27], s64 offen offset:2048 lds
    buffer_load_dwordx4 v7, s[24:27], s64 offen offset:3072 lds
    s_waitcnt vmcnt(6)
    s_waitcnt lgkmcnt(0)
    s_barrier
    ds_read_b64_tr_b16 v[48:49], v30 offset:0
    ds_read_b64_tr_b16 v[50:51], v30 offset:512
    ds_read_b64_tr_b16 v[52:53], v31 offset:0
    ds_read_b64_tr_b16 v[54:55], v31 offset:512
    ds_read_b64_tr_b16 v[56:57], v23
    ds_read_b128 v[128:131], v12 offset:0
    ds_read_b64_tr_b16 v[32:33], v16 offset:0
    ds_read_b64_tr_b16 v[34:35], v16 offset:512
    ds_read_b64_tr_b16 v[36:37], v17 offset:0
    ds_read_b64_tr_b16 v[38:39], v17 offset:512
    ds_read_b64_tr_b16 v[40:41], v18 offset:0
    ds_read_b64_tr_b16 v[42:43], v18 offset:512
    ds_read_b64_tr_b16 v[44:45], v19 offset:0
    ds_read_b64_tr_b16 v[46:47], v19 offset:512
    s_cmp_lg_u32 s48, 0
    s_cbranch_scc1 GA_NONL
    buffer_load_dword v0, off, s[44:47], 0 sc1
GA_NONL:
    s_waitcnt lgkmcnt(9)
    v_dot2c_f32_bf16 v28, s68, v48
    v_dot2c_f32_bf16 v29, s68, v52
    v_dot2c_f32_bf16 v20, s68, v56
    v_dot2c_f32_bf16 v28, s68, v49
    v_dot2c_f32_bf16 v29, s68, v53
    v_dot2c_f32_bf16 v20, s68, v57
    v_dot2c_f32_bf16 v28, s68, v50
    v_dot2c_f32_bf16 v29, s68, v54
    v_dot2c_f32_bf16 v28, s68, v51
    v_dot2c_f32_bf16 v29, s68, v55
    s_lshl_b32 s55, s48, 2
    s_add_u32 s55, s55, 155648
    v_lshlrev_b32 v26, 1, v2
    v_add_u32 v26, s55, v26
    ds_write_b32 v26, v28
    v_and_b32 v27, 15, v1
    v_lshlrev_b32 v27, 5, v27
    s_lshr_b32 s55, s48, 2
    s_lshl_b32 s55, s55, 9
    s_lshl_b32 s57, s56, 3
    s_add_u32 s55, s55, s57
    ds_write_b32 v26, v29 offset:2048
    v_mov_b32 v3, v20
    v_bfe_u32 v26, v1, 4, 1
    v_lshl_add_u32 v27, v26, 2, v27
    v_permlane32_swap_b32 v20, v3
    s_add_u32 s55, s55, 159744
    v_add_u32 v27, s55, v27
    v_add_f32 v3, v3, v20
    ds_write_b32 v27, v3
    s_waitcnt lgkmcnt(0)
    s_waitcnt lgkmcnt(6)
    v_mfma_f32_32x32x16_bf16 v[64:79], v[32:35], v[128:131], 0
    ds_read_b128 v[132:135], v13 offset:0
    ds_read_b64_tr_b16 v[48:49], v16 offset:2048
    ds_read_b64_tr_b16 v[50:51], v16 offset:2560
    s_add_u32 s65, s3, 2
    s_and_b32 s65, s65, 7
    s_lshl_b32 s67, s65, 7
    s_mul_i32 s65, s65, 229376
    s_add_u32 m0, s61, 98304
    s_nop 0
    buffer_load_dwordx4 v8, s[28:31], s65 offen lds
    s_waitcnt lgkmcnt(7)
    v_mfma_f32_32x32x16_bf16 v[80:95], v[36:39], v[128:131], 0
    ds_read_b64_tr_b16 v[52:53], v17 offset:2048
    ds_read_b64_tr_b16 v[54:55], v17 offset:2560
    s_waitcnt lgkmcnt(7)
    v_mfma_f32_32x32x16_bf16 v[96:111], v[40:43], v[128:131], 0
    ds_read_b64_tr_b16 v[56:57], v18 offset:2048
    ds_read_b64_tr_b16 v[58:59], v18 offset:2560
    s_add_u32 m0, s62, 98304
    s_nop 0
    buffer_load_dwordx4 v9, s[32:35], s65 offen lds
    s_waitcnt lgkmcnt(7)
    v_mfma_f32_32x32x16_bf16 v[112:127], v[44:47], v[128:131], 0
    ds_read_b64_tr_b16 v[60:61], v19 offset:2048
    ds_read_b64_tr_b16 v[62:63], v19 offset:2560
    s_waitcnt lgkmcnt(6)
    v_mfma_f32_32x32x16_bf16 v[64:79], v[48:51], v[132:135], v[64:79]
    ds_read_b128 v[136:139], v14 offset:0
    ds_read_b64_tr_b16 v[32:33], v16 offset:4096
    ds_read_b64_tr_b16 v[34:35], v16 offset:4608
    s_add_u32 m0, s60, 98304
    s_mov_b32 s64, s67
    buffer_load_dwordx4 v4, s[24:27], s64 offen offset:0 lds
    s_waitcnt lgkmcnt(7)
    v_mfma_f32_32x32x16_bf16 v[80:95], v[52:55], v[132:135], v[80:95]
    ds_read_b64_tr_b16 v[36:37], v17 offset:4096
    ds_read_b64_tr_b16 v[38:39], v17 offset:4608
    s_waitcnt lgkmcnt(7)
    v_mfma_f32_32x32x16_bf16 v[96:111], v[56:59], v[132:135], v[96:111]
    ds_read_b64_tr_b16 v[40:41], v18 offset:4096
    ds_read_b64_tr_b16 v[42:43], v18 offset:4608
    buffer_load_dwordx4 v5, s[24:27], s64 offen offset:1024 lds
    s_waitcnt lgkmcnt(7)
    v_mfma_f32_32x32x16_bf16 v[112:127], v[60:63], v[132:135], v[112:127]
    ds_read_b64_tr_b16 v[44:45], v19 offset:4096
    ds_read_b64_tr_b16 v[46:47], v19 offset:4608
    s_waitcnt lgkmcnt(6)
    v_mfma_f32_32x32x16_bf16 v[64:79], v[32:35], v[136:139], v[64:79]
    ds_read_b128 v[140:143], v15 offset:0
    ds_read_b64_tr_b16 v[48:49], v16 offset:6144
    ds_read_b64_tr_b16 v[50:51], v16 offset:6656
    buffer_load_dwordx4 v6, s[24:27], s64 offen offset:2048 lds
    s_waitcnt lgkmcnt(7)
    v_mfma_f32_32x32x16_bf16 v[80:95], v[36:39], v[136:139], v[80:95]
    ds_read_b64_tr_b16 v[52:53], v17 offset:6144
    ds_read_b64_tr_b16 v[54:55], v17 offset:6656
    s_waitcnt lgkmcnt(7)
    v_mfma_f32_32x32x16_bf16 v[96:111], v[40:43], v[136:139], v[96:111]
    ds_read_b64_tr_b16 v[56:57], v18 offset:6144
    ds_read_b64_tr_b16 v[58:59], v18 offset:6656
    buffer_load_dwordx4 v7, s[24:27], s64 offen offset:3072 lds
    s_waitcnt lgkmcnt(7)
    v_mfma_f32_32x32x16_bf16 v[112:127], v[44:47], v[136:139], v[112:127]
    ds_read_b64_tr_b16 v[60:61], v19 offset:6144
    ds_read_b64_tr_b16 v[62:63], v19 offset:6656
    s_waitcnt lgkmcnt(6)
    v_mfma_f32_32x32x16_bf16 v[64:79], v[48:51], v[140:143], v[64:79]
    s_waitcnt lgkmcnt(4)
    v_mfma_f32_32x32x16_bf16 v[80:95], v[52:55], v[140:143], v[80:95]
    s_waitcnt lgkmcnt(2)
    v_mfma_f32_32x32x16_bf16 v[96:111], v[56:59], v[140:143], v[96:111]
    s_waitcnt lgkmcnt(0)
    v_mfma_f32_32x32x16_bf16 v[112:127], v[60:63], v[140:143], v[112:127]
    s_waitcnt vmcnt(6)
    s_waitcnt lgkmcnt(0)
    s_barrier
    s_cmp_ge_u32 s48, 3
    s_cbranch_scc1 GA_NORED
    s_lshl_b32 s55, s48, 6
    v_add_u32 v26, s55, v1
    v_min_u32 v27, 159, v26
    v_lshlrev_b32 v27, 5, v27
    v_add_u32 v27, 155648, v27
    ds_read_b128 v[48:51], v27
    ds_read_b128 v[52:55], v27 offset:16
    v_cmp_lt_u32 vcc, 159, v26
    v_lshlrev_b32 v26, 2, v26
    v_add_u32 v27, 160768, v26
    ds_read_b32 v56, v27
    s_sub_u32 s55, s36, 23068672
    s_lshl_b32 s55, s55, 3
    s_add_u32 s55, s55, 23592960
    s_waitcnt lgkmcnt(0)
    v_add_f32 v48, v48, v52
    v_add_f32 v49, v49, v53
    v_add_f32 v50, v50, v54
    v_add_f32 v51, v51, v55
    v_add_f32 v48, v48, v49
    v_add_f32 v50, v50, v51
    v_add_f32 v48, v48, v50
    v_cndmask_b32 v20, v48, v56, vcc
    buffer_store_dword v20, v26, s[40:43], s55 offen sc1
GA_NORED:
    ds_read_b128 v[144:147], v12 offset:49152
    ds_read_b64_tr_b16 v[32:33], v16 offset:49152
    ds_read_b64_tr_b16 v[34:35], v16 offset:49664
    ds_read_b64_tr_b16 v[36:37], v17 offset:49152
    ds_read_b64_tr_b16 v[38:39], v17 offset:49664
    ds_read_b64_tr_b16 v[40:41], v18 offset:49152
    ds_read_b64_tr_b16 v[42:43], v18 offset:49664
    ds_read_b64_tr_b16 v[44:45], v19 offset:49152
    ds_read_b64_tr_b16 v[46:47], v19 offset:49664
    s_waitcnt lgkmcnt(6)
    v_mfma_f32_32x32x16_bf16 v[64:79], v[32:35], v[144:147], v[64:79]
    ds_read_b128 v[148:151], v13 offset:49152
    ds_read_b64_tr_b16 v[48:49], v16 offset:51200
    ds_read_b64_tr_b16 v[50:51], v16 offset:51712
    s_add_u32 s65, s3, 3
    s_and_b32 s65, s65, 7
    s_lshl_b32 s67, s65, 7
    s_mul_i32 s65, s65, 229376
    s_add_u32 m0, s61, 0
    s_nop 0
    buffer_load_dwordx4 v8, s[28:31], s65 offen lds
    s_waitcnt lgkmcnt(7)
    v_mfma_f32_32x32x16_bf16 v[80:95], v[36:39], v[144:147], v[80:95]
    ds_read_b64_tr_b16 v[52:53], v17 offset:51200
    ds_read_b64_tr_b16 v[54:55], v17 offset:51712
    s_waitcnt lgkmcnt(7)
    v_mfma_f32_32x32x16_bf16 v[96:111], v[40:43], v[144:147], v[96:111]
    ds_read_b64_tr_b16 v[56:57], v18 offset:51200
    ds_read_b64_tr_b16 v[58:59], v18 offset:51712
    s_add_u32 m0, s62, 0
    s_nop 0
    buffer_load_dwordx4 v9, s[32:35], s65 offen lds
    s_waitcnt lgkmcnt(7)
    v_mfma_f32_32x32x16_bf16 v[112:127], v[44:47], v[144:147], v[112:127]
    ds_read_b64_tr_b16 v[60:61], v19 offset:51200
    ds_read_b64_tr_b16 v[62:63], v19 offset:51712
    s_waitcnt lgkmcnt(6)
    v_mfma_f32_32x32x16_bf16 v[64:79], v[48:51], v[148:151], v[64:79]
    ds_read_b128 v[152:155], v14 offset:49152
    ds_read_b64_tr_b16 v[32:33], v16 offset:53248
    ds_read_b64_tr_b16 v[34:35], v16 offset:53760
    s_add_u32 m0, s60, 0
    s_mov_b32 s64, s67
    buffer_load_dwordx4 v4, s[24:27], s64 offen offset:0 lds
    s_waitcnt lgkmcnt(7)
    v_mfma_f32_32x32x16_bf16 v[80:95], v[52:55], v[148:151], v[80:95]
    ds_read_b64_tr_b16 v[36:37], v17 offset:53248
    ds_read_b64_tr_b16 v[38:39], v17 offset:53760
    s_waitcnt lgkmcnt(7)
    v_mfma_f32_32x32x16_bf16 v[96:111], v[56:59], v[148:151], v[96:111]
    ds_read_b64_tr_b16 v[40:41], v18 offset:53248
    ds_read_b64_tr_b16 v[42:43], v18 offset:53760
    buffer_load_dwordx4 v5, s[24:27], s64 offen offset:1024 lds
    s_waitcnt lgkmcnt(7)
    v_mfma_f32_32x32x16_bf16 v[112:127], v[60:63], v[148:151], v[112:127]
    ds_read_b64_tr_b16 v[44:45], v19 offset:53248
    ds_read_b64_tr_b16 v[46:47], v19 offset:53760
    s_waitcnt lgkmcnt(6)
    v_mfma_f32_32x32x16_bf16 v[64:79], v[32:35], v[152:155], v[64:79]
    ds_read_b128 v[156:159], v15 offset:49152
    ds_read_b64_tr_b16 v[48:49], v16 offset:55296
    ds_read_b64_tr_b16 v[50:51], v16 offset:55808
    buffer_load_dwordx4 v6, s[24:27], s64 offen offset:2048 lds
    s_waitcnt lgkmcnt(7)
    v_mfma_f32_32x32x16_bf16 v[80:95], v[36:39], v[152:155], v[80:95]
    ds_read_b64_tr_b16 v[52:53], v17 offset:55296
    ds_read_b64_tr_b16 v[54:55], v17 offset:55808
    s_waitcnt lgkmcnt(7)
    v_mfma_f32_32x32x16_bf16 v[96:111], v[40:43], v[152:155], v[96:111]
    ds_read_b64_tr_b16 v[56:57], v18 offset:55296
    ds_read_b64_tr_b16 v[58:59], v18 offset:55808
    buffer_load_dwordx4 v7, s[24:27], s64 offen offset:3072 lds
    s_waitcnt lgkmcnt(7)
    v_mfma_f32_32x32x16_bf16 v[112:127], v[44:47], v[152:155], v[112:127]
    ds_read_b64_tr_b16 v[60:61], v19 offset:55296
    ds_read_b64_tr_b16 v[62:63], v19 offset:55808
    s_waitcnt lgkmcnt(6)
    v_mfma_f32_32x32x16_bf16 v[64:79], v[48:51], v[156:159], v[64:79]
    s_and_b32 s55, s49, 1
    s_mul_i32 s55, s55, 114688
    s_bitcmp1_b32 s49, 1
    s_cselect_b32 s72, s14, s12
    s_cselect_b32 s73, s15, s13
    s_mov_b32 s74, 0x1c0000
    s_mov_b32 s75, 0x00020000
    buffer_load_dwordx4 v[252:255], v24, s[72:75], s55 offen
    s_waitcnt lgkmcnt(4)
    v_mfma_f32_32x32x16_bf16 v[80:95], v[52:55], v[156:159], v[80:95]
    s_waitcnt lgkmcnt(2)
    v_mfma_f32_32x32x16_bf16 v[96:111], v[56:59], v[156:159], v[96:111]
    s_waitcnt lgkmcnt(0)
    v_mfma_f32_32x32x16_bf16 v[112:127], v[60:63], v[156:159], v[112:127]
    v_add_u32 v12, 98304, v12
    v_add_u32 v13, 98304, v13
    v_add_u32 v14, 98304, v14
    v_add_u32 v15, 98304, v15
    v_add_u32 v16, 98304, v16
    v_add_u32 v17, 98304, v17
    v_add_u32 v18, 98304, v18
    v_add_u32 v19, 98304, v19
    s_waitcnt vmcnt(7)
    s_waitcnt lgkmcnt(0)
    s_barrier
    ds_read_b128 v[160:163], v12 offset:0
    ds_read_b64_tr_b16 v[32:33], v16 offset:0
    ds_read_b64_tr_b16 v[34:35], v16 offset:512
    ds_read_b64_tr_b16 v[36:37], v17 offset:0
    ds_read_b64_tr_b16 v[38:39], v17 offset:512
    ds_read_b64_tr_b16 v[40:41], v18 offset:0
    ds_read_b64_tr_b16 v[42:43], v18 offset:512
    ds_read_b64_tr_b16 v[44:45], v19 offset:0
    ds_read_b64_tr_b16 v[46:47], v19 offset:512
    s_waitcnt lgkmcnt(6)
    v_mfma_f32_32x32x16_bf16 v[64:79], v[32:35], v[160:163], v[64:79]
    ds_read_b128 v[164:167], v13 offset:0
    ds_read_b64_tr_b16 v[48:49], v16 offset:2048
    ds_read_b64_tr_b16 v[50:51], v16 offset:2560
    s_add_u32 s65, s3, 4
    s_and_b32 s65, s65, 7
    s_lshl_b32 s67, s65, 7
    s_mul_i32 s65, s65, 229376
    s_add_u32 m0, s61, 49152
    s_nop 0
    buffer_load_dwordx4 v8, s[28:31], s65 offen lds
    s_waitcnt lgkmcnt(7)
    v_mfma_f32_32x32x16_bf16 v[80:95], v[36:39], v[160:163], v[80:95]
    ds_read_b64_tr_b16 v[52:53], v17 offset:2048
    ds_read_b64_tr_b16 v[54:55], v17 offset:2560
    s_waitcnt lgkmcnt(7)
    v_mfma_f32_32x32x16_bf16 v[96:111], v[40:43], v[160:163], v[96:111]
    ds_read_b64_tr_b16 v[56:57], v18 offset:2048
    ds_read_b64_tr_b16 v[58:59], v18 offset:2560
    s_add_u32 m0, s62, 49152
    s_nop 0
    buffer_load_dwordx4 v9, s[32:35], s65 offen lds
    s_waitcnt lgkmcnt(7)
    v_mfma_f32_32x32x16_bf16 v[112:127], v[44:47], v[160:163], v[112:127]
    ds_read_b64_tr_b16 v[60:61], v19 offset:2048
    ds_read_b64_tr_b16 v[62:63], v19 offset:2560
    s_waitcnt lgkmcnt(6)
    v_mfma_f32_32x32x16_bf16 v[64:79], v[48:51], v[164:167], v[64:79]
    ds_read_b128 v[168:171], v14 offset:0
    ds_read_b64_tr_b16 v[32:33], v16 offset:4096
    ds_read_b64_tr_b16 v[34:35], v16 offset:4608
    s_add_u32 m0, s60, 49152
    s_mov_b32 s64, s67
    buffer_load_dwordx4 v4, s[24:27], s64 offen offset:0 lds
    s_waitcnt lgkmcnt(7)
    v_mfma_f32_32x32x16_bf16 v[80:95], v[52:55], v[164:167], v[80:95]
    ds_read_b64_tr_b16 v[36:37], v17 offset:4096
    ds_read_b64_tr_b16 v[38:39], v17 offset:4608
    s_waitcnt lgkmcnt(7)
    v_mfma_f32_32x32x16_bf16 v[96:111], v[56:59], v[164:167], v[96:111]
    ds_read_b64_tr_b16 v[40:41], v18 offset:4096
    ds_read_b64_tr_b16 v[42:43], v18 offset:4608
    buffer_load_dwordx4 v5, s[24:27], s64 offen offset:1024 lds
    s_waitcnt lgkmcnt(7)
    v_mfma_f32_32x32x16_bf16 v[112:127], v[60:63], v[164:167], v[112:127]
    ds_read_b64_tr_b16 v[44:45], v19 offset:4096
    ds_read_b64_tr_b16 v[46:47], v19 offset:4608
    s_waitcnt lgkmcnt(6)
    v_mfma_f32_32x32x16_bf16 v[64:79], v[32:35], v[168:171], v[64:79]
    ds_read_b128 v[172:175], v15 offset:0
    ds_read_b64_tr_b16 v[48:49], v16 offset:6144
    ds_read_b64_tr_b16 v[50:51], v16 offset:6656
    buffer_load_dwordx4 v6, s[24:27], s64 offen offset:2048 lds
    s_waitcnt lgkmcnt(7)
    v_mfma_f32_32x32x16_bf16 v[80:95], v[36:39], v[168:171], v[80:95]
    ds_read_b64_tr_b16 v[52:53], v17 offset:6144
    ds_read_b64_tr_b16 v[54:55], v17 offset:6656
    s_waitcnt lgkmcnt(7)
    v_mfma_f32_32x32x16_bf16 v[96:111], v[40:43], v[168:171], v[96:111]
    ds_read_b64_tr_b16 v[56:57], v18 offset:6144
    ds_read_b64_tr_b16 v[58:59], v18 offset:6656
    buffer_load_dwordx4 v7, s[24:27], s64 offen offset:3072 lds
    s_waitcnt lgkmcnt(7)
    v_mfma_f32_32x32x16_bf16 v[112:127], v[44:47], v[168:171], v[112:127]
    ds_read_b64_tr_b16 v[60:61], v19 offset:6144
    ds_read_b64_tr_b16 v[62:63], v19 offset:6656
    s_waitcnt lgkmcnt(6)
    v_mfma_f32_32x32x16_bf16 v[64:79], v[48:51], v[172:175], v[64:79]
    s_lshl_b32 s70, s51, 3
    s_add_u32 s70, s70, s49
    s_lshl_b32 s71, s48, 5
    s_add_u32 s70, s70, s71
    s_sub_u32 s70, s70, 32
    s_cmp_ge_u32 s70, 144
    s_cselect_b32 s57, 1, 0
    s_cselect_b32 s70, 0, s70
    s_cmp_lt_u32 s70, 112
    s_cselect_b32 s72, s16, s8
    s_cselect_b32 s73, s17, s9
    s_mov_b32 s71, 0x80000
    s_cselect_b32 s74, 0x1c0000, s71
    s_mov_b32 s75, 0x00020000
    s_cselect_b32 s71, 0, 112
    s_sub_u32 s70, s70, s71
    s_lshl_b32 s70, s70, 14
    s_and_b32 s71, s52, 3
    s_lshl_b32 s71, s71, 8
    s_add_u32 s70, s70, s71
    s_cmp_eq_u32 s57, 1
    s_cselect_b32 s70, 0x7f000000, s70
    s_add_u32 s71, s70, 0
    buffer_load_dwordx4 v[248:251], v246, s[72:75], s71 offen
    s_waitcnt lgkmcnt(4)
    v_mfma_f32_32x32x16_bf16 v[80:95], v[52:55], v[172:175], v[80:95]
    s_waitcnt lgkmcnt(2)
    v_mfma_f32_32x32x16_bf16 v[96:111], v[56:59], v[172:175], v[96:111]
    s_add_u32 s71, s70, 4096
    buffer_load_dwordx4 v[252:255], v246, s[72:75], s71 offen
    s_waitcnt lgkmcnt(0)
    v_mfma_f32_32x32x16_bf16 v[112:127], v[60:63], v[172:175], v[112:127]
    v_subrev_u32 v12, 98304, v12
    v_subrev_u32 v13, 98304, v13
    v_subrev_u32 v14, 98304, v14
    v_subrev_u32 v15, 98304, v15
    v_subrev_u32 v16, 98304, v16
    v_subrev_u32 v17, 98304, v17
    v_subrev_u32 v18, 98304, v18
    v_subrev_u32 v19, 98304, v19
    s_waitcnt vmcnt(9)
    s_barrier
    s_cmp_lg_u32 s48, 0
    s_cbranch_scc1 GA_NOREC
    s_mov_b32 s37, 262144
GA_NCHK:
    v_readfirstlane_b32 s39, v0
    s_cmp_lg_u32 s39, 0
    s_cbranch_scc1 GA_NOK
    s_sub_u32 s37, s37, 1
    s_cmp_eq_u32 s37, 0
    s_cbranch_scc1 GA_NOK
    s_sleep 4
    buffer_load_dword v0, off, s[44:47], 0 sc1
    s_waitcnt vmcnt(0)
    s_branch GA_NCHK
GA_NOK:
    s_and_b32 s39, s39, -8
GA_NOREC:
    s_cmp_lg_u32 s48, 0
    s_cbranch_scc1 GA_FL1
    s_add_u32 s37, s39, 1
    v_mov_b32 v0, s37
    s_mov_b32 exec_hi, 0
    buffer_store_dword v0, v11, s[40:43], s36 offen sc1
    s_mov_b32 exec_hi, -1
GA_FL1:
    ds_read_b128 v[176:179], v12 offset:0
    ds_read_b64_tr_b16 v[32:33], v16 offset:0
    ds_read_b64_tr_b16 v[34:35], v16 offset:512
    ds_read_b64_tr_b16 v[36:37], v17 offset:0
    ds_read_b64_tr_b16 v[38:39], v17 offset:512
    ds_read_b64_tr_b16 v[40:41], v18 offset:0
    ds_read_b64_tr_b16 v[42:43], v18 offset:512
    ds_read_b64_tr_b16 v[44:45], v19 offset:0
    ds_read_b64_tr_b16 v[46:47], v19 offset:512
    s_waitcnt lgkmcnt(6)
    v_mfma_f32_32x32x16_bf16 v[64:79], v[32:35], v[176:179], v[64:79]
    ds_read_b128 v[180:183], v13 offset:0
    ds_read_b64_tr_b16 v[48:49], v16 offset:2048
    ds_read_b64_tr_b16 v[50:51], v16 offset:2560
    s_add_u32 s65, s3, 5
    s_and_b32 s65, s65, 7
    s_lshl_b32 s67, s65, 7
    s_mul_i32 s65, s65, 229376
    s_add_u32 m0, s61, 98304
    s_nop 0
    buffer_load_dwordx4 v8, s[28:31], s65 offen lds
    s_waitcnt lgkmcnt(7)
    v_mfma_f32_32x32x16_bf16 v[80:95], v[36:39], v[176:179], v[80:95]
    ds_read_b64_tr_b16 v[52:53], v17 offset:2048
    ds_read_b64_tr_b16 v[54:55], v17 offset:2560
    s_waitcnt lgkmcnt(7)
    v_mfma_f32_32x32x16_bf16 v[96:111], v[40:43], v[176:179], v[96:111]
    ds_read_b64_tr_b16 v[56:57], v18 offset:2048
    ds_read_b64_tr_b16 v[58:59], v18 offset:2560
    s_add_u32 m0, s62, 98304
    s_nop 0
    buffer_load_dwordx4 v9, s[32:35], s65 offen lds
    s_waitcnt lgkmcnt(7)
    v_mfma_f32_32x32x16_bf16 v[112:127], v[44:47], v[176:179], v[112:127]
    ds_read_b64_tr_b16 v[60:61], v19 offset:2048
    ds_read_b64_tr_b16 v[62:63], v19 offset:2560
    s_waitcnt lgkmcnt(6)
    v_mfma_f32_32x32x16_bf16 v[64:79], v[48:51], v[180:183], v[64:79]
    ds_read_b128 v[184:187], v14 offset:0
    ds_read_b64_tr_b16 v[32:33], v16 offset:4096
    ds_read_b64_tr_b16 v[34:35], v16 offset:4608
    s_add_u32 m0, s60, 98304
    s_mov_b32 s64, s67
    buffer_load_dwordx4 v4, s[24:27], s64 offen offset:0 lds
    s_waitcnt lgkmcnt(7)
    v_mfma_f32_32x32x16_bf16 v[80:95], v[52:55], v[180:183], v[80:95]
    ds_read_b64_tr_b16 v[36:37], v17 offset:4096
    ds_read_b64_tr_b16 v[38:39], v17 offset:4608
    s_waitcnt lgkmcnt(7)
    v_mfma_f32_32x32x16_bf16 v[96:111], v[56:59], v[180:183], v[96:111]
    ds_read_b64_tr_b16 v[40:41], v18 offset:4096
    ds_read_b64_tr_b16 v[42:43], v18 offset:4608
    buffer_load_dwordx4 v5, s[24:27], s64 offen offset:1024 lds
    s_waitcnt lgkmcnt(7)
    v_mfma_f32_32x32x16_bf16 v[112:127], v[60:63], v[180:183], v[112:127]
    ds_read_b64_tr_b16 v[44:45], v19 offset:4096
    ds_read_b64_tr_b16 v[46:47], v19 offset:4608
    s_waitcnt lgkmcnt(6)
    v_mfma_f32_32x32x16_bf16 v[64:79], v[32:35], v[184:187], v[64:79]
    ds_read_b128 v[188:191], v15 offset:0
    ds_read_b64_tr_b16 v[48:49], v16 offset:6144
    ds_read_b64_tr_b16 v[50:51], v16 offset:6656
    buffer_load_dwordx4 v6, s[24:27], s64 offen offset:2048 lds
    s_waitcnt lgkmcnt(7)
    v_mfma_f32_32x32x16_bf16 v[80:95], v[36:39], v[184:187], v[80:95]
    ds_read_b64_tr_b16 v[52:53], v17 offset:6144
    ds_read_b64_tr_b16 v[54:55], v17 offset:6656
    s_waitcnt lgkmcnt(7)
    v_mfma_f32_32x32x16_bf16 v[96:111], v[40:43], v[184:187], v[96:111]
    ds_read_b64_tr_b16 v[56:57], v18 offset:6144
    ds_read_b64_tr_b16 v[58:59], v18 offset:6656
    buffer_load_dwordx4 v7, s[24:27], s64 offen offset:3072 lds
    s_waitcnt lgkmcnt(7)
    v_mfma_f32_32x32x16_bf16 v[112:127], v[44:47], v[184:187], v[112:127]
    ds_read_b64_tr_b16 v[60:61], v19 offset:6144
    ds_read_b64_tr_b16 v[62:63], v19 offset:6656
    s_waitcnt lgkmcnt(6)
    v_mfma_f32_32x32x16_bf16 v[64:79], v[48:51], v[188:191], v[64:79]
    s_add_u32 s71, s70, 8192
    buffer_load_dwordx4 v[248:251], v246, s[72:75], s71 offen
    s_waitcnt lgkmcnt(4)
    v_mfma_f32_32x32x16_bf16 v[80:95], v[52:55], v[188:191], v[80:95]
    s_waitcnt lgkmcnt(2)
    v_mfma_f32_32x32x16_bf16 v[96:111], v[56:59], v[188:191], v[96:111]
    s_add_u32 s71, s70, 12288
    buffer_load_dwordx4 v[252:255], v246, s[72:75], s71 offen
    s_waitcnt lgkmcnt(0)
    v_mfma_f32_32x32x16_bf16 v[112:127], v[60:63], v[188:191], v[112:127]
    s_waitcnt vmcnt(10)
    s_barrier
    ds_read_b128 v[192:195], v12 offset:49152
    ds_read_b64_tr_b16 v[32:33], v16 offset:49152
    ds_read_b64_tr_b16 v[34:35], v16 offset:49664
    ds_read_b64_tr_b16 v[36:37], v17 offset:49152
    ds_read_b64_tr_b16 v[38:39], v17 offset:49664
    ds_read_b64_tr_b16 v[40:41], v18 offset:49152
    ds_read_b64_tr_b16 v[42:43], v18 offset:49664
    ds_read_b64_tr_b16 v[44:45], v19 offset:49152
    ds_read_b64_tr_b16 v[46:47], v19 offset:49664
    s_waitcnt lgkmcnt(6)
    v_mfma_f32_32x32x16_bf16 v[64:79], v[32:35], v[192:195], v[64:79]
    ds_read_b128 v[196:199], v13 offset:49152
    ds_read_b64_tr_b16 v[48:49], v16 offset:51200
    ds_read_b64_tr_b16 v[50:51], v16 offset:51712
    s_add_u32 s65, s3, 6
    s_and_b32 s65, s65, 7
    s_lshl_b32 s67, s65, 7
    s_mul_i32 s65, s65, 229376
    s_add_u32 m0, s61, 0
    s_nop 0
    buffer_load_dwordx4 v8, s[28:31], s65 offen lds
    s_waitcnt lgkmcnt(7)
    v_mfma_f32_32x32x16_bf16 v[80:95], v[36:39], v[192:195], v[80:95]
    ds_read_b64_tr_b16 v[52:53], v17 offset:51200
    ds_read_b64_tr_b16 v[54:55], v17 offset:51712
    s_waitcnt lgkmcnt(7)
    v_mfma_f32_32x32x16_bf16 v[96:111], v[40:43], v[192:195], v[96:111]
    ds_read_b64_tr_b16 v[56:57], v18 offset:51200
    ds_read_b64_tr_b16 v[58:59], v18 offset:51712
    s_add_u32 m0, s62, 0
    s_nop 0
    buffer_load_dwordx4 v9, s[32:35], s65 offen lds
    s_waitcnt lgkmcnt(7)
    v_mfma_f32_32x32x16_bf16 v[112:127], v[44:47], v[192:195], v[112:127]
    ds_read_b64_tr_b16 v[60:61], v19 offset:51200
    ds_read_b64_tr_b16 v[62:63], v19 offset:51712
    s_waitcnt lgkmcnt(6)
    v_mfma_f32_32x32x16_bf16 v[64:79], v[48:51], v[196:199], v[64:79]
    ds_read_b128 v[200:203], v14 offset:49152
    ds_read_b64_tr_b16 v[32:33], v16 offset:53248
    ds_read_b64_tr_b16 v[34:35], v16 offset:53760
    s_add_u32 m0, s60, 0
    s_mov_b32 s64, s67
    buffer_load_dwordx4 v4, s[24:27], s64 offen offset:0 lds
    s_waitcnt lgkmcnt(7)
    v_mfma_f32_32x32x16_bf16 v[80:95], v[52:55], v[196:199], v[80:95]
    ds_read_b64_tr_b16 v[36:37], v17 offset:53248
    ds_read_b64_tr_b16 v[38:39], v17 offset:53760
    s_waitcnt lgkmcnt(7)
    v_mfma_f32_32x32x16_bf16 v[96:111], v[56:59], v[196:199], v[96:111]
    ds_read_b64_tr_b16 v[40:41], v18 offset:53248
    ds_read_b64_tr_b16 v[42:43], v18 offset:53760
    buffer_load_dwordx4 v5, s[24:27], s64 offen offset:1024 lds
    s_waitcnt lgkmcnt(7)
    v_mfma_f32_32x32x16_bf16 v[112:127], v[60:63], v[196:199], v[112:127]
    ds_read_b64_tr_b16 v[44:45], v19 offset:53248
    ds_read_b64_tr_b16 v[46:47], v19 offset:53760
    s_waitcnt lgkmcnt(6)
    v_mfma_f32_32x32x16_bf16 v[64:79], v[32:35], v[200:203], v[64:79]
    ds_read_b128 v[204:207], v15 offset:49152
    ds_read_b64_tr_b16 v[48:49], v16 offset:55296
    ds_read_b64_tr_b16 v[50:51], v16 offset:55808
    buffer_load_dwordx4 v6, s[24:27], s64 offen offset:2048 lds
    s_waitcnt lgkmcnt(7)
    v_mfma_f32_32x32x16_bf16 v[80:95], v[36:39], v[200:203], v[80:95]
    ds_read_b64_tr_b16 v[52:53], v17 offset:55296
    ds_read_b64_tr_b16 v[54:55], v17 offset:55808
    s_waitcnt lgkmcnt(7)
    v_mfma_f32_32x32x16_bf16 v[96:111], v[40:43], v[200:203], v[96:111]
    ds_read_b64_tr_b16 v[56:57], v18 offset:55296
    ds_read_b64_tr_b16 v[58:59], v18 offset:55808
    buffer_load_dwordx4 v7, s[24:27], s64 offen offset:3072 lds
    s_waitcnt lgkmcnt(7)
    v_mfma_f32_32x32x16_bf16 v[112:127], v[44:47], v[200:203], v[112:127]
    ds_read_b64_tr_b16 v[60:61], v19 offset:55296
    ds_read_b64_tr_b16 v[62:63], v19 offset:55808
    s_waitcnt lgkmcnt(6)
    v_mfma_f32_32x32x16_bf16 v[64:79], v[48:51], v[204:207], v[64:79]
    s_waitcnt lgkmcnt(4)
    v_mfma_f32_32x32x16_bf16 v[80:95], v[52:55], v[204:207], v[80:95]
    s_waitcnt lgkmcnt(2)
    v_mfma_f32_32x32x16_bf16 v[96:111], v[56:59], v[204:207], v[96:111]
    s_waitcnt lgkmcnt(0)
    v_mfma_f32_32x32x16_bf16 v[112:127], v[60:63], v[204:207], v[112:127]
    v_add_u32 v12, 98304, v12
    v_add_u32 v13, 98304, v13
    v_add_u32 v14, 98304, v14
    v_add_u32 v15, 98304, v15
    v_add_u32 v16, 98304, v16
    v_add_u32 v17, 98304, v17
    v_add_u32 v18, 98304, v18
    v_add_u32 v19, 98304, v19
    s_waitcnt vmcnt(8)
    s_barrier
    s_cmp_lg_u32 s48, 0
    s_cbranch_scc1 GA_NOP1
    v_lshlrev_b32 v28, 3, v1
    v_add_u32 v28, s49, v28
    s_lshl_b32 s55, s50, 3
    v_and_b32 v29, 7, v1
    v_add_u32 v29, s55, v29
    v_cmp_lt_u32 vcc, 31, v1
    s_nop 1
    v_cndmask_b32 v28, v28, v29, vcc
    v_lshlrev_b32 v28, 7, v28
    v_add_u32 v28, 23068672, v28
    buffer_load_dword v29, v28, s[40:43], 0 offen sc1
GA_NOP1:
    ds_read_b128 v[208:211], v12 offset:0
    ds_read_b64_tr_b16 v[32:33], v16 offset:0
    ds_read_b64_tr_b16 v[34:35], v16 offset:512
    ds_read_b64_tr_b16 v[36:37], v17 offset:0
    ds_read_b64_tr_b16 v[38:39], v17 offset:512
    ds_read_b64_tr_b16 v[40:41], v18 offset:0
    ds_read_b64_tr_b16 v[42:43], v18 offset:512
    ds_read_b64_tr_b16 v[44:45], v19 offset:0
    ds_read_b64_tr_b16 v[46:47], v19 offset:512
    s_waitcnt lgkmcnt(6)
    v_mfma_f32_32x32x16_bf16 v[64:79], v[32:35], v[208:211], v[64:79]
    ds_read_b128 v[212:215], v13 offset:0
    ds_read_b64_tr_b16 v[48:49], v16 offset:2048
    ds_read_b64_tr_b16 v[50:51], v16 offset:2560
    s_add_u32 s65, s3, 7
    s_and_b32 s65, s65, 7
    s_lshl_b32 s67, s65, 7
    s_mul_i32 s65, s65, 229376
    s_add_u32 m0, s61, 49152
    s_nop 0
    buffer_load_dwordx4 v8, s[28:31], s65 offen lds
    s_waitcnt lgkmcnt(7)
    v_mfma_f32_32x32x16_bf16 v[80:95], v[36:39], v[208:211], v[80:95]
    ds_read_b64_tr_b16 v[52:53], v17 offset:2048
    ds_read_b64_tr_b16 v[54:55], v17 offset:2560
    s_waitcnt lgkmcnt(7)
    v_mfma_f32_32x32x16_bf16 v[96:111], v[40:43], v[208:211], v[96:111]
    ds_read_b64_tr_b16 v[56:57], v18 offset:2048
    ds_read_b64_tr_b16 v[58:59], v18 offset:2560
    s_add_u32 m0, s62, 49152
    s_nop 0
    buffer_load_dwordx4 v9, s[32:35], s65 offen lds
    s_waitcnt lgkmcnt(7)
    v_mfma_f32_32x32x16_bf16 v[112:127], v[44:47], v[208:211], v[112:127]
    ds_read_b64_tr_b16 v[60:61], v19 offset:2048
    ds_read_b64_tr_b16 v[62:63], v19 offset:2560
    s_waitcnt lgkmcnt(6)
    v_mfma_f32_32x32x16_bf16 v[64:79], v[48:51], v[212:215], v[64:79]
    ds_read_b128 v[216:219], v14 offset:0
    ds_read_b64_tr_b16 v[32:33], v16 offset:4096
    ds_read_b64_tr_b16 v[34:35], v16 offset:4608
    s_add_u32 m0, s60, 49152
    s_mov_b32 s64, s67
    buffer_load_dwordx4 v4, s[24:27], s64 offen offset:0 lds
    s_waitcnt lgkmcnt(7)
    v_mfma_f32_32x32x16_bf16 v[80:95], v[52:55], v[212:215], v[80:95]
    ds_read_b64_tr_b16 v[36:37], v17 offset:4096
    ds_read_b64_tr_b16 v[38:39], v17 offset:4608
    s_waitcnt lgkmcnt(7)
    v_mfma_f32_32x32x16_bf16 v[96:111], v[56:59], v[212:215], v[96:111]
    ds_read_b64_tr_b16 v[40:41], v18 offset:4096
    ds_read_b64_tr_b16 v[42:43], v18 offset:4608
    buffer_load_dwordx4 v5, s[24:27], s64 offen offset:1024 lds
    s_waitcnt lgkmcnt(7)
    v_mfma_f32_32x32x16_bf16 v[112:127], v[60:63], v[212:215], v[112:127]
    ds_read_b64_tr_b16 v[44:45], v19 offset:4096
    ds_read_b64_tr_b16 v[46:47], v19 offset:4608
    s_waitcnt lgkmcnt(6)
    v_mfma_f32_32x32x16_bf16 v[64:79], v[32:35], v[216:219], v[64:79]
    ds_read_b128 v[220:223], v15 offset:0
    ds_read_b64_tr_b16 v[48:49], v16 offset:6144
    ds_read_b64_tr_b16 v[50:51], v16 offset:6656
    buffer_load_dwordx4 v6, s[24:27], s64 offen offset:2048 lds
    s_waitcnt lgkmcnt(7)
    v_mfma_f32_32x32x16_bf16 v[80:95], v[36:39], v[216:219], v[80:95]
    ds_read_b64_tr_b16 v[52:53], v17 offset:6144
    ds_read_b64_tr_b16 v[54:55], v17 offset:6656
    s_waitcnt lgkmcnt(7)
    v_mfma_f32_32x32x16_bf16 v[96:111], v[40:43], v[216:219], v[96:111]
    ds_read_b64_tr_b16 v[56:57], v18 offset:6144
    ds_read_b64_tr_b16 v[58:59], v18 offset:6656
    buffer_load_dwordx4 v7, s[24:27], s64 offen offset:3072 lds
    s_waitcnt lgkmcnt(7)
    v_mfma_f32_32x32x16_bf16 v[112:127], v[44:47], v[216:219], v[112:127]
    ds_read_b64_tr_b16 v[60:61], v19 offset:6144
    ds_read_b64_tr_b16 v[62:63], v19 offset:6656
    s_waitcnt lgkmcnt(6)
    v_mfma_f32_32x32x16_bf16 v[64:79], v[48:51], v[220:223], v[64:79]
    s_waitcnt lgkmcnt(4)
    v_mfma_f32_32x32x16_bf16 v[80:95], v[52:55], v[220:223], v[80:95]
    s_waitcnt lgkmcnt(2)
    v_mfma_f32_32x32x16_bf16 v[96:111], v[56:59], v[220:223], v[96:111]
    s_waitcnt lgkmcnt(0)
    v_mfma_f32_32x32x16_bf16 v[112:127], v[60:63], v[220:223], v[112:127]
    v_subrev_u32 v12, 98304, v12
    v_subrev_u32 v13, 98304, v13
    v_subrev_u32 v14, 98304, v14
    v_subrev_u32 v15, 98304, v15
    v_subrev_u32 v16, 98304, v16
    v_subrev_u32 v17, 98304, v17
    v_subrev_u32 v18, 98304, v18
    v_subrev_u32 v19, 98304, v19
    s_waitcnt vmcnt(7)
    s_cmp_lg_u32 s48, 0
    s_cbranch_scc1 GA_P1_OK
    s_waitcnt vmcnt(6)
    s_mov_b32 s37, 262144
    s_add_u32 s38, s39, 1
GA_P1_CHK:
    v_subrev_u32 v29, s38, v29
    v_cmp_lt_u32 vcc, 3, v29
    s_cmp_eq_u64 vcc, 0
    s_cbranch_scc1 GA_P1_OK
    s_sub_u32 s37, s37, 1
    s_cmp_eq_u32 s37, 0
    s_cbranch_scc1 GA_P1_OK
    s_sleep 1
    buffer_load_dword v29, v28, s[40:43], 0 offen sc1
    s_waitcnt vmcnt(0)
    s_branch GA_P1_CHK
GA_P1_OK:
    s_barrier
    s_lshl_b32 s55, s50, 3
    s_add_u32 s55, s55, s48
    s_lshl_b32 s55, s55, 10
    s_add_u32 s55, s55, 23592960
    s_lshl_b32 s57, s48, 10
    s_add_u32 m0, s57, 122880
    s_add_u32 s73, s57, 123648
    buffer_load_dwordx4 v2, s[40:43], s55 offen sc1 lds
    v_bfe_u32 v26, v1, 3, 2
    v_lshlrev_b32 v26, 13, v26
    v_and_b32 v27, 7, v1
    v_lshl_add_u32 v26, v27, 3, v26
    s_lshl_b32 s55, s48, 5
    s_add_u32 s55, s55, s49
    s_lshl_b32 s55, s55, 10
    s_add_u32 s55, s55, 23593600
    buffer_load_dwordx2 v[22:23], v26, s[40:43], s55 offen sc1
    ds_read_b128 v[224:227], v12 offset:0
    ds_read_b64_tr_b16 v[32:33], v16 offset:0
    ds_read_b64_tr_b16 v[34:35], v16 offset:512
    ds_read_b64_tr_b16 v[36:37], v17 offset:0
    ds_read_b64_tr_b16 v[38:39], v17 offset:512
    ds_read_b64_tr_b16 v[40:41], v18 offset:0
    ds_read_b64_tr_b16 v[42:43], v18 offset:512
    ds_read_b64_tr_b16 v[44:45], v19 offset:0
    ds_read_b64_tr_b16 v[46:47], v19 offset:512
    s_waitcnt lgkmcnt(6)
    v_mfma_f32_32x32x16_bf16 v[64:79], v[32:35], v[224:227], v[64:79]
    ds_read_b128 v[228:231], v13 offset:0
    ds_read_b64_tr_b16 v[48:49], v16 offset:2048
    ds_read_b64_tr_b16 v[50:51], v16 offset:2560
    s_add_u32 m0, s63, 131072
    s_mov_b32 s64, 0
    buffer_load_dwordx4 v24, s[28:31], s64 offen lds
    s_waitcnt lgkmcnt(7)
    v_mfma_f32_32x32x16_bf16 v[80:95], v[36:39], v[224:227], v[80:95]
    ds_read_b64_tr_b16 v[52:53], v17 offset:2048
    ds_read_b64_tr_b16 v[54:55], v17 offset:2560
    s_waitcnt lgkmcnt(7)
    v_mfma_f32_32x32x16_bf16 v[96:111], v[40:43], v[224:227], v[96:111]
    ds_read_b64_tr_b16 v[56:57], v18 offset:2048
    ds_read_b64_tr_b16 v[58:59], v18 offset:2560
    s_add_u32 m0, s63, 147456
    s_nop 0
    buffer_load_dwordx4 v25, s[32:35], s64 offen lds
    s_waitcnt lgkmcnt(7)
    v_mfma_f32_32x32x16_bf16 v[112:127], v[44:47], v[224:227], v[112:127]
    ds_read_b64_tr_b16 v[60:61], v19 offset:2048
    ds_read_b64_tr_b16 v[62:63], v19 offset:2560
    s_waitcnt lgkmcnt(6)
    v_mfma_f32_32x32x16_bf16 v[64:79], v[48:51], v[228:231], v[64:79]
    ds_read_b128 v[232:235], v14 offset:0
    ds_read_b64_tr_b16 v[32:33], v16 offset:4096
    ds_read_b64_tr_b16 v[34:35], v16 offset:4608
    s_add_u32 m0, s63, 132096
    s_mov_b32 s64, 114688
    buffer_load_dwordx4 v24, s[28:31], s64 offen lds
    s_waitcnt lgkmcnt(7)
    v_mfma_f32_32x32x16_bf16 v[80:95], v[52:55], v[228:231], v[80:95]
    ds_read_b64_tr_b16 v[36:37], v17 offset:4096
    ds_read_b64_tr_b16 v[38:39], v17 offset:4608
    s_waitcnt lgkmcnt(7)
    v_mfma_f32_32x32x16_bf16 v[96:111], v[56:59], v[228:231], v[96:111]
    ds_read_b64_tr_b16 v[40:41], v18 offset:4096
    ds_read_b64_tr_b16 v[42:43], v18 offset:4608
    s_add_u32 m0, s63, 148480
    s_nop 0
    buffer_load_dwordx4 v25, s[32:35], s64 offen lds
    s_waitcnt lgkmcnt(7)
    v_mfma_f32_32x32x16_bf16 v[112:127], v[60:63], v[228:231], v[112:127]
    ds_read_b64_tr_b16 v[44:45], v19 offset:4096
    ds_read_b64_tr_b16 v[46:47], v19 offset:4608
    s_waitcnt lgkmcnt(6)
    v_mfma_f32_32x32x16_bf16 v[64:79], v[32:35], v[232:235], v[64:79]
    ds_read_b128 v[236:239], v15 offset:0
    ds_read_b64_tr_b16 v[48:49], v16 offset:6144
    ds_read_b64_tr_b16 v[50:51], v16 offset:6656
    s_waitcnt lgkmcnt(7)
    v_mfma_f32_32x32x16_bf16 v[80:95], v[36:39], v[232:235], v[80:95]
    ds_read_b64_tr_b16 v[52:53], v17 offset:6144
    ds_read_b64_tr_b16 v[54:55], v17 offset:6656
    s_waitcnt lgkmcnt(7)
    v_mfma_f32_32x32x16_bf16 v[96:111], v[40:43], v[232:235], v[96:111]
    ds_read_b64_tr_b16 v[56:57], v18 offset:6144
    ds_read_b64_tr_b16 v[58:59], v18 offset:6656
    s_waitcnt lgkmcnt(7)
    v_mfma_f32_32x32x16_bf16 v[112:127], v[44:47], v[232:235], v[112:127]
    ds_read_b64_tr_b16 v[60:61], v19 offset:6144
    ds_read_b64_tr_b16 v[62:63], v19 offset:6656
    s_waitcnt lgkmcnt(6)
    v_mfma_f32_32x32x16_bf16 v[64:79], v[48:51], v[236:239], v[64:79]
    s_waitcnt lgkmcnt(4)
    v_mfma_f32_32x32x16_bf16 v[80:95], v[52:55], v[236:239], v[80:95]
    s_waitcnt lgkmcnt(2)
    v_mfma_f32_32x32x16_bf16 v[96:111], v[56:59], v[236:239], v[96:111]
    s_waitcnt lgkmcnt(0)
    v_mfma_f32_32x32x16_bf16 v[112:127], v[60:63], v[236:239], v[112:127]
    s_waitcnt vmcnt(6)
    s_barrier
    ds_read_b128 v[240:243], v12 offset:49152
    ds_read_b64_tr_b16 v[32:33], v16 offset:49152
    ds_read_b64_tr_b16 v[34:35], v16 offset:49664
    ds_read_b64_tr_b16 v[36:37], v17 offset:49152
    ds_read_b64_tr_b16 v[38:39], v17 offset:49664
    ds_read_b64_tr_b16 v[40:41], v18 offset:49152
    ds_read_b64_tr_b16 v[42:43], v18 offset:49664
    ds_read_b64_tr_b16 v[44:45], v19 offset:49152
    ds_read_b64_tr_b16 v[46:47], v19 offset:49664
    s_waitcnt lgkmcnt(6)
    v_mfma_f32_32x32x16_bf16 v[64:79], v[32:35], v[240:243], v[64:79]
    ds_read_b128 v[244:247], v13 offset:49152
    ds_read_b64_tr_b16 v[48:49], v16 offset:51200
    ds_read_b64_tr_b16 v[50:51], v16 offset:51712
    s_waitcnt lgkmcnt(7)
    v_mfma_f32_32x32x16_bf16 v[80:95], v[36:39], v[240:243], v[80:95]
    ds_read_b64_tr_b16 v[52:53], v17 offset:51200
    ds_read_b64_tr_b16 v[54:55], v17 offset:51712
    s_waitcnt lgkmcnt(7)
    v_mfma_f32_32x32x16_bf16 v[96:111], v[40:43], v[240:243], v[96:111]
    ds_read_b64_tr_b16 v[56:57], v18 offset:51200
    ds_read_b64_tr_b16 v[58:59], v18 offset:51712
    s_waitcnt lgkmcnt(7)
    v_mfma_f32_32x32x16_bf16 v[112:127], v[44:47], v[240:243], v[112:127]
    ds_read_b64_tr_b16 v[60:61], v19 offset:51200
    ds_read_b64_tr_b16 v[62:63], v19 offset:51712
    s_waitcnt lgkmcnt(6)
    v_mfma_f32_32x32x16_bf16 v[64:79], v[48:51], v[244:247], v[64:79]
    ds_read_b128 v[248:251], v14 offset:49152
    ds_read_b64_tr_b16 v[32:33], v16 offset:53248
    ds_read_b64_tr_b16 v[34:35], v16 offset:53760
    s_waitcnt lgkmcnt(7)
    v_mfma_f32_32x32x16_bf16 v[80:95], v[52:55], v[244:247], v[80:95]
    ds_read_b64_tr_b16 v[36:37], v17 offset:53248
    ds_read_b64_tr_b16 v[38:39], v17 offset:53760
    s_waitcnt lgkmcnt(7)
    v_mfma_f32_32x32x16_bf16 v[96:111], v[56:59], v[244:247], v[96:111]
    ds_read_b64_tr_b16 v[40:41], v18 offset:53248
    ds_read_b64_tr_b16 v[42:43], v18 offset:53760
    s_waitcnt lgkmcnt(7)
    v_mfma_f32_32x32x16_bf16 v[112:127], v[60:63], v[244:247], v[112:127]
    ds_read_b64_tr_b16 v[44:45], v19 offset:53248
    ds_read_b64_tr_b16 v[46:47], v19 offset:53760
    s_waitcnt lgkmcnt(6)
    v_mfma_f32_32x32x16_bf16 v[64:79], v[32:35], v[248:251], v[64:79]
    ds_read_b128 v[252:255], v15 offset:49152
    ds_read_b64_tr_b16 v[48:49], v16 offset:55296
    ds_read_b64_tr_b16 v[50:51], v16 offset:55808
    s_waitcnt lgkmcnt(7)
    v_mfma_f32_32x32x16_bf16 v[80:95], v[36:39], v[248:251], v[80:95]
    ds_read_b64_tr_b16 v[52:53], v17 offset:55296
    ds_read_b64_tr_b16 v[54:55], v17 offset:55808
    s_waitcnt lgkmcnt(7)
    v_mfma_f32_32x32x16_bf16 v[96:111], v[40:43], v[248:251], v[96:111]
    ds_read_b64_tr_b16 v[56:57], v18 offset:55296
    ds_read_b64_tr_b16 v[58:59], v18 offset:55808
    s_waitcnt lgkmcnt(7)
    v_mfma_f32_32x32x16_bf16 v[112:127], v[44:47], v[248:251], v[112:127]
    ds_read_b64_tr_b16 v[60:61], v19 offset:55296
    ds_read_b64_tr_b16 v[62:63], v19 offset:55808
    s_waitcnt lgkmcnt(6)
    v_mfma_f32_32x32x16_bf16 v[64:79], v[48:51], v[252:255], v[64:79]
    s_waitcnt lgkmcnt(4)
    v_mfma_f32_32x32x16_bf16 v[80:95], v[52:55], v[252:255], v[80:95]
    s_waitcnt lgkmcnt(2)
    v_mfma_f32_32x32x16_bf16 v[96:111], v[56:59], v[252:255], v[96:111]
    s_waitcnt lgkmcnt(0)
    v_mfma_f32_32x32x16_bf16 v[112:127], v[60:63], v[252:255], v[112:127]
    v_bfe_u32 v24, v1, 4, 1
    v_lshrrev_b32 v25, 5, v1
    v_bfe_u32 v26, v1, 2, 2
    v_and_b32 v27, 3, v1
    v_lshl_add_u32 v26, v25, 3, v26
    v_lshlrev_b32 v14, 5, v26
    v_lshl_add_u32 v14, v27, 3, v14
    v_mul_u32_u24 v15, 16512, v24
    v_add_u32 v14, v14, v15
    v_add_u32 v14, 131072, v14
    v_xor_b32 v15, 128, v14
    v_mov_b32 v5, 0
    v_mov_b32 v6, 0
    v_mov_b32 v7, 0
    v_mov_b32 v21, 0
    v_and_b32 v30, 31, v1
    v_lshlrev_b32 v24, 2, v30
    v_mul_u32_u24 v30, 4096, v25
    v_add_u32 v30, v30, v24
    v_add_u32 v30, 122880, v30
    s_mul_i32 s75, s54, 112
    s_waitcnt vmcnt(0)
    v_mov_b32 v20, v22
    v_mov_b32 v28, v23
    v_mov_b32 v22, 0
    v_mov_b32 v23, 0
    v_mul_f32 v29, 0xbfb8aa3b, v28
    s_waitcnt lgkmcnt(0)
    s_barrier
    v_add_u32 v31, 0, v30
    ds_read2st64_b32 v[24:25], v31 offset0:0 offset1:4
    ds_read2st64_b32 v[26:27], v31 offset0:8 offset1:12
    v_add_u32 v31, 128, v30
    ds_read2st64_b32 v[16:17], v31 offset0:0 offset1:4
    ds_read2st64_b32 v[18:19], v31 offset0:8 offset1:12
    ds_read_b64_tr_b16 v[48:49], v14 offset:0
    ds_read_b64_tr_b16 v[50:51], v15 offset:0
    ds_read_b64_tr_b16 v[52:53], v14 offset:512
    ds_read_b64_tr_b16 v[54:55], v15 offset:512
    ds_read_b64_tr_b16 v[56:57], v14 offset:1024
    ds_read_b64_tr_b16 v[58:59], v15 offset:1024
    s_lshl_b32 s74, s53, 2
    s_add_u32 s66, s75, s74
    s_lshl_b32 s66, s66, 10
    s_add_u32 s66, s66, 8388608
    s_add_u32 s67, s75, s53
    s_add_u32 s67, s67, 96
    s_lshl_b32 s67, s67, 10
    s_add_u32 s67, s67, 8388608
    s_lshl_b32 s70, s51, 3
    s_add_u32 s70, s70, s49
    s_lshl_b32 s71, s48, 5
    s_add_u32 s70, s70, s71
    s_sub_u32 s70, s70, 32
    s_cmp_ge_u32 s70, 144
    s_cselect_b32 s65, 1, 0
    s_cselect_b32 s70, 0, s70
    s_cmp_lt_u32 s70, 112
    s_cselect_b32 s72, s16, s8
    s_cselect_b32 s73, s17, s9
    s_mov_b32 s71, 0x80000
    s_cselect_b32 s74, 0x1c0000, s71
    s_mov_b32 s75, 0x00020000
    s_mov_b32 s71, 18874368
    s_cselect_b32 s63, 16777216, s71
    s_cselect_b32 s71, 0, 112
    s_sub_u32 s70, s70, s71
    s_lshl_b32 s70, s70, 14
    s_and_b32 s71, s52, 3
    s_lshl_b32 s71, s71, 1
    s_lshl_b32 s57, s71, 11
    s_add_u32 s63, s63, s57
    s_add_u32 s63, s63, s70
    s_lshl_b32 s71, s71, 7
    s_add_u32 s70, s70, s71
    v_lshrrev_b32 v12, 4, v1
    v_and_b32 v13, 15, v1
    v_lshlrev_b32 v13, 4, v13
    v_lshl_add_u32 v12, v12, 10, v13
    s_cmp_eq_u32 s65, 1
    s_cselect_b32 s70, 0x7f000000, s70
    s_cselect_b32 s57, 0x20000, s60
    s_add_u32 m0, s57, 65536
    s_add_u32 s71, s70, 0
    buffer_load_dwordx4 v12, s[72:75], s71 offen lds
    s_add_u32 m0, s57, 66560
    s_add_u32 s71, s70, 4096
    buffer_load_dwordx4 v12, s[72:75], s71 offen lds
    s_add_u32 m0, s57, 67584
    s_add_u32 s71, s70, 8192
    buffer_load_dwordx4 v12, s[72:75], s71 offen lds
    s_add_u32 m0, s57, 68608
    s_add_u32 s71, s70, 12288
    buffer_load_dwordx4 v12, s[72:75], s71 offen lds
    v_lshrrev_b32 v12, 5, v1
    v_bfe_u32 v13, v1, 2, 2
    v_lshl_add_u32 v12, v12, 2, v13
    v_lshlrev_b32 v12, 8, v12
    v_bfe_u32 v13, v1, 4, 1
    v_lshl_add_u32 v12, v13, 5, v12
    v_and_b32 v13, 3, v1
    v_lshl_add_u32 v12, v13, 3, v12
    s_cmp_eq_u32 s65, 1
    s_cselect_b32 s63, 0x7f000000, s63
    s_cselect_b32 s71, 4096, s60
    s_add_u32 s71, s71, 65536
    v_add_u32 v12, s71, v12
    s_waitcnt lgkmcnt(4)
    v_mfma_f32_32x32x16_bf16 v[32:47], v[48:51], v[128:131], 0
    ds_read_b64_tr_b16 v[60:61], v14 offset:1536
    ds_read_b64_tr_b16 v[62:63], v15 offset:1536
    v_add_f32 v24, v24, v25
    v_add_f32 v26, v26, v27
    v_add_f32 v24, v24, v26
    v_cvt_pk_bf16_f32 v25, v24, v24
    v_lshlrev_b32 v25, 16, v25
    v_sub_f32 v25, v24, v25
    v_cvt_pk_bf16_f32 v4, v24, v25
    s_nop 1
    v_mfma_f32_32x32x16_bf16 v[64:79], v[4:7], v[20:23], v[64:79]
    s_waitcnt lgkmcnt(4)
    v_mfma_f32_32x32x16_bf16 v[32:47], v[52:55], v[132:135], v[32:47]
    ds_read_b64_tr_b16 v[48:49], v14 offset:2048
    ds_read_b64_tr_b16 v[50:51], v15 offset:2048
    v_add_f32 v16, v16, v17
    v_add_f32 v18, v18, v19
    v_add_f32 v16, v16, v18
    v_cvt_pk_bf16_f32 v17, v16, v16
    v_lshlrev_b32 v17, 16, v17
    v_sub_f32 v17, v16, v17
    v_cvt_pk_bf16_f32 v4, v16, v17
    s_nop 1
    v_mfma_f32_32x32x16_bf16 v[80:95], v[4:7], v[20:23], v[80:95]
    s_waitcnt lgkmcnt(4)
    v_mfma_f32_32x32x16_bf16 v[32:47], v[56:59], v[136:139], v[32:47]
    ds_read_b64_tr_b16 v[52:53], v14 offset:2560
    ds_read_b64_tr_b16 v[54:55], v15 offset:2560
    v_add_u32 v31, 256, v30
    ds_read2st64_b32 v[24:25], v31 offset0:0 offset1:4
    ds_read2st64_b32 v[26:27], v31 offset0:8 offset1:12
    v_add_u32 v31, 384, v30
    ds_read2st64_b32 v[16:17], v31 offset0:0 offset1:4
    ds_read2st64_b32 v[18:19], v31 offset0:8 offset1:12
    s_waitcnt lgkmcnt(0)
    v_add_f32 v24, v24, v25
    v_add_f32 v26, v26, v27
    v_add_f32 v24, v24, v26
    v_cvt_pk_bf16_f32 v25, v24, v24
    v_lshlrev_b32 v25, 16, v25
    v_sub_f32 v25, v24, v25
    v_cvt_pk_bf16_f32 v4, v24, v25
    s_nop 1
    v_mfma_f32_32x32x16_bf16 v[96:111], v[4:7], v[20:23], v[96:111]
    s_waitcnt lgkmcnt(4)
    v_mfma_f32_32x32x16_bf16 v[32:47], v[60:63], v[140:143], v[32:47]
    ds_read_b64_tr_b16 v[56:57], v14 offset:3072
    ds_read_b64_tr_b16 v[58:59], v15 offset:3072
    v_add_f32 v16, v16, v17
    v_add_f32 v18, v18, v19
    v_add_f32 v16, v16, v18
    v_cvt_pk_bf16_f32 v17, v16, v16
    v_lshlrev_b32 v17, 16, v17
    v_sub_f32 v17, v16, v17
    v_cvt_pk_bf16_f32 v4, v16, v17
    s_nop 1
    v_mfma_f32_32x32x16_bf16 v[112:127], v[4:7], v[20:23], v[112:127]
    s_waitcnt lgkmcnt(4)
    v_mfma_f32_32x32x16_bf16 v[32:47], v[48:51], v[144:147], v[32:47]
    ds_read_b64_tr_b16 v[60:61], v14 offset:3584
    ds_read_b64_tr_b16 v[62:63], v15 offset:3584
    v_add_u32 v31, 512, v30
    ds_read2st64_b32 v[24:25], v31 offset0:0 offset1:4
    ds_read2st64_b32 v[26:27], v31 offset0:8 offset1:12
    s_waitcnt lgkmcnt(0)
    v_add_f32 v24, v24, v25
    v_add_f32 v26, v26, v27
    v_add_f32 v24, v24, v26
    v_cvt_pk_bf16_f32 v25, v24, v24
    v_lshlrev_b32 v25, 16, v25
    v_sub_f32 v25, v24, v25
    s_waitcnt lgkmcnt(4)
    v_mfma_f32_32x32x16_bf16 v[32:47], v[52:55], v[148:151], v[32:47]
    ds_read_b64_tr_b16 v[48:49], v14 offset:4096
    ds_read_b64_tr_b16 v[50:51], v15 offset:4096
    v_cvt_pk_bf16_f32 v4, v24, v25
    s_nop 1
    v_mfma_f32_32x32x16_bf16 v[32:47], v[4:7], v[20:23], v[32:47]
    v_mul_f32 v64, v29, v64
    v_mul_f32 v65, v29, v65
    v_mul_f32 v66, v29, v66
    v_mul_f32 v67, v29, v67
    v_exp_f32 v64, v64
    s_waitcnt lgkmcnt(4)
    v_mfma_f32_32x32x16_bf16 v[32:47], v[56:59], v[152:155], v[32:47]
    ds_read_b64_tr_b16 v[52:53], v14 offset:4608
    ds_read_b64_tr_b16 v[54:55], v15 offset:4608
    v_exp_f32 v65, v65
    v_exp_f32 v66, v66
    v_exp_f32 v67, v67
    v_add_f32 v64, 1.0, v64
    v_add_f32 v65, 1.0, v65
    v_add_f32 v66, 1.0, v66
    s_waitcnt lgkmcnt(4)
    v_mfma_f32_32x32x16_bf16 v[32:47], v[60:63], v[156:159], v[32:47]
    ds_read_b64_tr_b16 v[56:57], v14 offset:5120
    ds_read_b64_tr_b16 v[58:59], v15 offset:5120
    v_add_f32 v67, 1.0, v67
    v_rcp_f32 v64, v64
    v_rcp_f32 v65, v65
    v_rcp_f32 v66, v66
    v_rcp_f32 v67, v67
    s_waitcnt lgkmcnt(4)
    v_mfma_f32_32x32x16_bf16 v[32:47], v[48:51], v[160:163], v[32:47]
    ds_read_b64_tr_b16 v[60:61], v14 offset:5632
    ds_read_b64_tr_b16 v[62:63], v15 offset:5632
    v_mul_f32 v64, v64, v72
    v_mul_f32 v65, v65, v73
    v_mul_f32 v66, v66, v74
    v_mul_f32 v67, v67, v75
    v_mul_f32 v68, v29, v68
    v_mul_f32 v69, v29, v69
    v_mul_f32 v70, v29, v70
    v_mul_f32 v71, v29, v71
    v_exp_f32 v68, v68
    s_waitcnt lgkmcnt(4)
    v_mfma_f32_32x32x16_bf16 v[32:47], v[52:55], v[164:167], v[32:47]
    ds_read_b64_tr_b16 v[48:49], v14 offset:6144
    ds_read_b64_tr_b16 v[50:51], v15 offset:6144
    v_exp_f32 v69, v69
    v_exp_f32 v70, v70
    v_exp_f32 v71, v71
    v_add_f32 v68, 1.0, v68
    v_add_f32 v69, 1.0, v69
    s_waitcnt lgkmcnt(4)
    v_mfma_f32_32x32x16_bf16 v[32:47], v[56:59], v[168:171], v[32:47]
    ds_read_b64_tr_b16 v[52:53], v14 offset:6656
    ds_read_b64_tr_b16 v[54:55], v15 offset:6656
    v_add_f32 v70, 1.0, v70
    v_add_f32 v71, 1.0, v71
    v_rcp_f32 v68, v68
    v_rcp_f32 v69, v69
    v_rcp_f32 v70, v70
    v_rcp_f32 v71, v71
    s_waitcnt vmcnt(0)
    ds_read_b64_tr_b16 v[128:129], v12 offset:0
    ds_read_b64_tr_b16 v[130:131], v12 offset:2048
    ds_read_b64_tr_b16 v[132:133], v12 offset:64
    ds_read_b64_tr_b16 v[134:135], v12 offset:2112
    ds_read_b64_tr_b16 v[136:137], v12 offset:128
    ds_read_b64_tr_b16 v[138:139], v12 offset:2176
    ds_read_b64_tr_b16 v[140:141], v12 offset:192
    ds_read_b64_tr_b16 v[142:143], v12 offset:2240
    s_waitcnt lgkmcnt(0)
    buffer_store_dwordx4 v[128:131], v2, s[40:43], s63 offen offset:0 sc1
    buffer_store_dwordx4 v[132:135], v2, s[40:43], s63 offen offset:1024 sc1
    buffer_store_dwordx4 v[136:139], v2, s[40:43], s63 offen offset:2048 sc1
    buffer_store_dwordx4 v[140:143], v2, s[40:43], s63 offen offset:3072 sc1
    s_waitcnt lgkmcnt(4)
    v_mfma_f32_32x32x16_bf16 v[32:47], v[60:63], v[172:175], v[32:47]
    ds_read_b64_tr_b16 v[56:57], v14 offset:7168
    ds_read_b64_tr_b16 v[58:59], v15 offset:7168
    v_mul_f32 v68, v68, v76
    v_mul_f32 v69, v69, v77
    v_mul_f32 v70, v70, v78
    v_mul_f32 v71, v71, v79
    v_cvt_pk_bf16_f32 v144, v64, v65
    v_cvt_pk_bf16_f32 v145, v66, v67
    v_cvt_pk_bf16_f32 v146, v68, v69
    v_cvt_pk_bf16_f32 v147, v70, v71
    s_waitcnt lgkmcnt(4)
    v_mfma_f32_32x32x16_bf16 v[32:47], v[48:51], v[176:179], v[32:47]
    ds_read_b64_tr_b16 v[60:61], v14 offset:7680
    ds_read_b64_tr_b16 v[62:63], v15 offset:7680
    v_mul_f32 v80, v29, v80
    v_mul_f32 v81, v29, v81
    v_mul_f32 v82, v29, v82
    v_mul_f32 v83, v29, v83
    v_exp_f32 v80, v80
    v_exp_f32 v81, v81
    v_exp_f32 v82, v82
    s_waitcnt lgkmcnt(4)
    v_mfma_f32_32x32x16_bf16 v[32:47], v[52:55], v[180:183], v[32:47]
    ds_read_b64_tr_b16 v[48:49], v14 offset:8192
    ds_read_b64_tr_b16 v[50:51], v15 offset:8192
    v_exp_f32 v83, v83
    v_add_f32 v80, 1.0, v80
    v_add_f32 v81, 1.0, v81
    v_add_f32 v82, 1.0, v82
    v_add_f32 v83, 1.0, v83
    v_rcp_f32 v80, v80
    s_waitcnt lgkmcnt(4)
    v_mfma_f32_32x32x16_bf16 v[32:47], v[56:59], v[184:187], v[32:47]
    ds_read_b64_tr_b16 v[52:53], v14 offset:8704
    ds_read_b64_tr_b16 v[54:55], v15 offset:8704
    v_rcp_f32 v81, v81
    v_rcp_f32 v82, v82
    v_rcp_f32 v83, v83
    v_mul_f32 v80, v80, v88
    v_mul_f32 v81, v81, v89
    v_mul_f32 v82, v82, v90
    s_waitcnt lgkmcnt(4)
    v_mfma_f32_32x32x16_bf16 v[32:47], v[60:63], v[188:191], v[32:47]
    ds_read_b64_tr_b16 v[56:57], v14 offset:9216
    ds_read_b64_tr_b16 v[58:59], v15 offset:9216
    v_mul_f32 v83, v83, v91
    v_mul_f32 v84, v29, v84
    v_mul_f32 v85, v29, v85
    v_mul_f32 v86, v29, v86
    v_mul_f32 v87, v29, v87
    v_exp_f32 v84, v84
    v_exp_f32 v85, v85
    s_waitcnt lgkmcnt(4)
    v_mfma_f32_32x32x16_bf16 v[32:47], v[48:51], v[192:195], v[32:47]
    ds_read_b64_tr_b16 v[60:61], v14 offset:9728
    ds_read_b64_tr_b16 v[62:63], v15 offset:9728
    v_exp_f32 v86, v86
    v_exp_f32 v87, v87
    v_add_f32 v84, 1.0, v84
    v_add_f32 v85, 1.0, v85
    v_add_f32 v86, 1.0, v86
    v_add_f32 v87, 1.0, v87
    v_rcp_f32 v84, v84
    s_cmp_lg_u32 s48, 0
    s_cbranch_scc1 GA_NOP2
    s_bfe_u32 s55, s2, 0x20001
    s_bfe_u32 s57, s2, 0x20003
    s_lshl_b32 s57, s57, 3
    s_add_u32 s55, s55, s57
    s_lshl_b32 s55, s55, 3
    v_min_u32 v9, 7, v1
    v_add_u32 v9, s55, v9
    v_lshlrev_b32 v9, 7, v9
    v_add_u32 v9, 23068672, v9
    buffer_load_dword v3, v9, s[40:43], 0 offen sc1
GA_NOP2:
    s_waitcnt lgkmcnt(4)
    v_mfma_f32_32x32x16_bf16 v[32:47], v[52:55], v[196:199], v[32:47]
    ds_read_b64_tr_b16 v[48:49], v14 offset:10240
    ds_read_b64_tr_b16 v[50:51], v15 offset:10240
    v_rcp_f32 v85, v85
    v_rcp_f32 v86, v86
    v_rcp_f32 v87, v87
    v_mul_f32 v84, v84, v92
    v_mul_f32 v85, v85, v93
    s_waitcnt lgkmcnt(4)
    v_mfma_f32_32x32x16_bf16 v[32:47], v[56:59], v[200:203], v[32:47]
    ds_read_b64_tr_b16 v[52:53], v14 offset:10752
    ds_read_b64_tr_b16 v[54:55], v15 offset:10752
    v_mul_f32 v86, v86, v94
    v_mul_f32 v87, v87, v95
    v_cvt_pk_bf16_f32 v148, v80, v81
    v_cvt_pk_bf16_f32 v149, v82, v83
    v_cvt_pk_bf16_f32 v150, v84, v85
    v_cvt_pk_bf16_f32 v151, v86, v87
    v_mul_f32 v96, v29, v96
    v_mul_f32 v97, v29, v97
    v_mul_f32 v98, v29, v98
    s_waitcnt lgkmcnt(4)
    v_mfma_f32_32x32x16_bf16 v[32:47], v[60:63], v[204:207], v[32:47]
    ds_read_b64_tr_b16 v[56:57], v14 offset:11264
    ds_read_b64_tr_b16 v[58:59], v15 offset:11264
    v_mul_f32 v99, v29, v99
    v_exp_f32 v96, v96
    v_exp_f32 v97, v97
    v_exp_f32 v98, v98
    v_exp_f32 v99, v99
    s_waitcnt lgkmcnt(4)
    v_mfma_f32_32x32x16_bf16 v[32:47], v[48:51], v[208:211], v[32:47]
    ds_read_b64_tr_b16 v[60:61], v14 offset:11776
    ds_read_b64_tr_b16 v[62:63], v15 offset:11776
    v_add_f32 v96, 1.0, v96
    v_add_f32 v97, 1.0, v97
    v_add_f32 v98, 1.0, v98
    v_add_f32 v99, 1.0, v99
    v_rcp_f32 v96, v96
    v_rcp_f32 v97, v97
    v_rcp_f32 v98, v98
    s_waitcnt lgkmcnt(4)
    v_mfma_f32_32x32x16_bf16 v[32:47], v[52:55], v[212:215], v[32:47]
    ds_read_b64_tr_b16 v[48:49], v14 offset:12288
    ds_read_b64_tr_b16 v[50:51], v15 offset:12288
    v_rcp_f32 v99, v99
    v_mul_f32 v96, v96, v104
    v_mul_f32 v97, v97, v105
    v_mul_f32 v98, v98, v106
    v_mul_f32 v99, v99, v107
    v_mul_f32 v100, v29, v100
    v_mul_f32 v101, v29, v101
    s_waitcnt lgkmcnt(4)
    v_mfma_f32_32x32x16_bf16 v[32:47], v[56:59], v[216:219], v[32:47]
    ds_read_b64_tr_b16 v[52:53], v14 offset:12800
    ds_read_b64_tr_b16 v[54:55], v15 offset:12800
    v_mul_f32 v102, v29, v102
    v_mul_f32 v103, v29, v103
    v_exp_f32 v100, v100
    v_exp_f32 v101, v101
    v_exp_f32 v102, v102
    v_exp_f32 v103, v103
    s_cmp_lg_u32 s48, 0
    s_cbranch_scc1 GA_P2_OK
    s_waitcnt vmcnt(0)
    s_mov_b32 s37, 262144
    s_add_u32 s38, s39, 2
GA_P2_CHK:
    v_subrev_u32 v3, s38, v3
    v_cmp_lt_u32 vcc, 3, v3
    s_cmp_eq_u64 vcc, 0
    s_cbranch_scc1 GA_P2_OK
    s_sub_u32 s37, s37, 1
    s_cmp_eq_u32 s37, 0
    s_cbranch_scc1 GA_P2_OK
    s_sleep 1
    buffer_load_dword v3, v9, s[40:43], 0 offen sc1
    s_waitcnt vmcnt(0)
    s_branch GA_P2_CHK
GA_P2_OK:
    s_barrier
    s_and_b32 s49, s2, 7
    s_bfe_u32 s50, s2, 0x20003
    s_lshl_b32 s51, s50, 3
    s_add_u32 s51, s51, s49
    s_lshl_b32 s49, s49, 2
    s_add_u32 s49, s49, s50
    s_lshr_b32 s50, s2, 5
    s_and_b32 s52, s48, 3
    s_lshr_b32 s53, s48, 2
    s_lshl_b32 s54, s51, 16
    s_lshl_b32 s55, s50, 3
    s_lshl_b32 s56, s52, 1
    s_add_u32 s55, s55, s56
    s_lshl_b32 s56, s55, 10
    s_add_u32 s56, s56, s54
    s_add_u32 s56, s56, 0
    s_lshl_b32 s57, s53, 15
    s_lshl_b32 s58, s52, 10
    s_add_u32 s58, s58, s57
    s_add_u32 s58, s58, s54
    s_add_u32 s59, s58, 4194304
    s_add_u32 s58, s58, 2097152
    s_lshl_b32 s57, s48, 10
    s_waitcnt lgkmcnt(4)
    v_mfma_f32_32x32x16_bf16 v[32:47], v[60:63], v[220:223], v[32:47]
    ds_read_b64_tr_b16 v[56:57], v14 offset:13312
    ds_read_b64_tr_b16 v[58:59], v15 offset:13312
    v_add_f32 v100, 1.0, v100
    v_add_f32 v101, 1.0, v101
    v_add_f32 v102, 1.0, v102
    v_add_f32 v103, 1.0, v103
    v_rcp_f32 v100, v100
    v_rcp_f32 v101, v101
    s_add_u32 m0, s57, 0
    s_add_u32 s62, s58, 0
    buffer_load_dwordx4 v2, s[40:43], s62 offen sc1 lds
    buffer_load_dwordx4 v[64:67], v2, s[40:43], s56 offen sc1
    s_waitcnt lgkmcnt(4)
    v_mfma_f32_32x32x16_bf16 v[32:47], v[48:51], v[224:227], v[32:47]
    ds_read_b64_tr_b16 v[60:61], v14 offset:13824
    ds_read_b64_tr_b16 v[62:63], v15 offset:13824
    v_rcp_f32 v102, v102
    v_rcp_f32 v103, v103
    v_mul_f32 v100, v100, v108
    v_mul_f32 v101, v101, v109
    v_mul_f32 v102, v102, v110
    v_mul_f32 v103, v103, v111
    v_cvt_pk_bf16_f32 v152, v96, v97
    buffer_load_dwordx4 v[68:71], v2, s[40:43], s56 offen offset:1024 sc1
    s_waitcnt lgkmcnt(4)
    v_mfma_f32_32x32x16_bf16 v[32:47], v[52:55], v[228:231], v[32:47]
    ds_read_b64_tr_b16 v[48:49], v14 offset:14336
    ds_read_b64_tr_b16 v[50:51], v15 offset:14336
    v_cvt_pk_bf16_f32 v153, v98, v99
    v_cvt_pk_bf16_f32 v154, v100, v101
    v_cvt_pk_bf16_f32 v155, v102, v103
    v_mul_f32 v112, v29, v112
    v_mul_f32 v113, v29, v113
    v_mul_f32 v114, v29, v114
    v_mul_f32 v115, v29, v115
    v_exp_f32 v112, v112
    s_add_u32 m0, s57, 8192
    s_add_u32 s62, s59, 0
    buffer_load_dwordx4 v2, s[40:43], s62 offen sc1 lds
    s_waitcnt lgkmcnt(4)
    v_mfma_f32_32x32x16_bf16 v[32:47], v[56:59], v[232:235], v[32:47]
    ds_read_b64_tr_b16 v[52:53], v14 offset:14848
    ds_read_b64_tr_b16 v[54:55], v15 offset:14848
    v_exp_f32 v113, v113
    v_exp_f32 v114, v114
    v_exp_f32 v115, v115
    v_add_f32 v112, 1.0, v112
    v_add_f32 v113, 1.0, v113
    v_add_f32 v114, 1.0, v114
    s_add_u32 m0, s57, 16384
    s_add_u32 s62, s58, 4096
    buffer_load_dwordx4 v2, s[40:43], s62 offen sc1 lds
    s_waitcnt lgkmcnt(4)
    v_mfma_f32_32x32x16_bf16 v[32:47], v[60:63], v[236:239], v[32:47]
    ds_read_b64_tr_b16 v[56:57], v14 offset:15360
    ds_read_b64_tr_b16 v[58:59], v15 offset:15360
    v_add_f32 v115, 1.0, v115
    v_rcp_f32 v112, v112
    v_rcp_f32 v113, v113
    v_rcp_f32 v114, v114
    v_rcp_f32 v115, v115
    s_add_u32 m0, s57, 24576
    s_add_u32 s62, s59, 4096
    buffer_load_dwordx4 v2, s[40:43], s62 offen sc1 lds
    s_waitcnt lgkmcnt(4)
    v_mfma_f32_32x32x16_bf16 v[32:47], v[48:51], v[240:243], v[32:47]
    ds_read_b64_tr_b16 v[60:61], v14 offset:15872
    ds_read_b64_tr_b16 v[62:63], v15 offset:15872
    v_mul_f32 v112, v112, v120
    v_mul_f32 v113, v113, v121
    v_mul_f32 v114, v114, v122
    v_mul_f32 v115, v115, v123
    v_mul_f32 v116, v29, v116
    v_mul_f32 v117, v29, v117
    v_mul_f32 v118, v29, v118
    v_mul_f32 v119, v29, v119
    v_exp_f32 v116, v116
    s_add_u32 m0, s57, 32768
    s_add_u32 s62, s58, 8192
    buffer_load_dwordx4 v2, s[40:43], s62 offen sc1 lds
    buffer_store_dwordx4 v[144:147], v2, s[40:43], s66 offen offset:0 sc1
    s_waitcnt lgkmcnt(4)
    v_mfma_f32_32x32x16_bf16 v[32:47], v[52:55], v[244:247], v[32:47]
    v_exp_f32 v117, v117
    v_exp_f32 v118, v118
    v_exp_f32 v119, v119
    v_add_f32 v116, 1.0, v116
    v_add_f32 v117, 1.0, v117
    s_add_u32 m0, s57, 40960
    s_add_u32 s62, s59, 8192
    buffer_load_dwordx4 v2, s[40:43], s62 offen sc1 lds
    buffer_store_dwordx4 v[148:151], v2, s[40:43], s66 offen offset:1024 sc1
    s_waitcnt lgkmcnt(2)
    v_mfma_f32_32x32x16_bf16 v[32:47], v[56:59], v[248:251], v[32:47]
    v_add_f32 v118, 1.0, v118
    v_add_f32 v119, 1.0, v119
    v_rcp_f32 v116, v116
    v_rcp_f32 v117, v117
    v_rcp_f32 v118, v118
    v_rcp_f32 v119, v119
    s_add_u32 m0, s57, 49152
    s_add_u32 s62, s58, 12288
    buffer_load_dwordx4 v2, s[40:43], s62 offen sc1 lds
    buffer_store_dwordx4 v[152:155], v2, s[40:43], s66 offen offset:2048 sc1
    s_waitcnt lgkmcnt(0)
    v_mfma_f32_32x32x16_bf16 v[32:47], v[60:63], v[252:255], v[32:47]
    v_mul_f32 v116, v116, v124
    v_mul_f32 v117, v117, v125
    v_mul_f32 v118, v118, v126
    v_mul_f32 v119, v119, v127
    v_cvt_pk_bf16_f32 v156, v112, v113
    v_cvt_pk_bf16_f32 v157, v114, v115
    v_cvt_pk_bf16_f32 v158, v116, v117
    v_cvt_pk_bf16_f32 v159, v118, v119
    s_add_u32 m0, s57, 57344
    s_add_u32 s62, s59, 12288
    buffer_load_dwordx4 v2, s[40:43], s62 offen sc1 lds
    s_nop 11
    v_mul_f32 v32, v29, v32
    v_mul_f32 v33, v29, v33
    v_mul_f32 v34, v29, v34
    v_mul_f32 v35, v29, v35
    v_exp_f32 v32, v32
    v_exp_f32 v33, v33
    v_exp_f32 v34, v34
    v_exp_f32 v35, v35
    v_add_f32 v32, 1.0, v32
    v_add_f32 v33, 1.0, v33
    v_add_f32 v34, 1.0, v34
    v_add_f32 v35, 1.0, v35
    v_rcp_f32 v32, v32
    v_rcp_f32 v33, v33
    v_rcp_f32 v34, v34
    v_rcp_f32 v35, v35
    v_mul_f32 v32, v32, v40
    v_mul_f32 v33, v33, v41
    v_mul_f32 v34, v34, v42
    v_mul_f32 v35, v35, v43
    v_mul_f32 v36, v29, v36
    v_mul_f32 v37, v29, v37
    v_mul_f32 v38, v29, v38
    v_mul_f32 v39, v29, v39
    v_exp_f32 v36, v36
    v_exp_f32 v37, v37
    v_exp_f32 v38, v38
    v_exp_f32 v39, v39
    v_add_f32 v36, 1.0, v36
    v_add_f32 v37, 1.0, v37
    v_add_f32 v38, 1.0, v38
    v_add_f32 v39, 1.0, v39
    v_rcp_f32 v36, v36
    v_rcp_f32 v37, v37
    v_rcp_f32 v38, v38
    v_rcp_f32 v39, v39
    v_mul_f32 v36, v36, v44
    v_mul_f32 v37, v37, v45
    v_mul_f32 v38, v38, v46
    v_mul_f32 v39, v39, v47
    v_cvt_pk_bf16_f32 v160, v32, v33
    v_cvt_pk_bf16_f32 v161, v34, v35
    v_cvt_pk_bf16_f32 v162, v36, v37
    v_cvt_pk_bf16_f32 v163, v38, v39
    s_mov_b32 s70, s66
    s_mov_b32 s71, s66
    s_mov_b32 s72, s67
    buffer_store_dwordx4 v[156:159], v2, s[40:43], s66 offen offset:3072 sc1
    buffer_store_dwordx4 v[160:163], v2, s[40:43], s67 offen sc1
    s_lshl_b32 s62, s53, 12
    v_add_u32 v4, s62, v2
    v_lshrrev_b32 v240, 5, v1
    v_and_b32 v3, 15, v1
    v_lshlrev_b32 v3, 4, v3
    v_lshl_add_u32 v3, v240, 8, v3
    v_add_u32 v3, 0x2000, v3
    v_add_u32 v5, s62, v3
    v_and_b32 v240, 27, v1
    v_cmp_eq_u32 vcc, 16, v240
    v_mov_b32 v240, 0x3f803f80
    v_mov_b32 v241, 0
    v_cndmask_b32 v240, v241, v240, vcc
    v_mov_b32 v24, v240
    v_mov_b32 v25, v240
    v_mov_b32 v26, v240
    v_mov_b32 v27, v240
    v_mov_b32 v28, v240
    v_mov_b32 v29, v240
    v_mov_b32 v30, v240
    v_mov_b32 v31, v240
    v_mov_b32 v32, v240
    v_mov_b32 v33, v240
    v_mov_b32 v34, v240
    v_mov_b32 v35, v240
    v_mov_b32 v36, v240
    v_mov_b32 v37, v240
    v_mov_b32 v38, v240
    v_mov_b32 v39, v240
    v_mov_b32 v112, 0
    v_mov_b32 v113, 0
    v_mov_b32 v114, 0
    v_mov_b32 v115, 0
    v_mov_b32 v116, 0
    v_mov_b32 v117, 0
    v_mov_b32 v118, 0
    v_mov_b32 v119, 0
    v_mov_b32 v120, 0
    v_mov_b32 v121, 0
    v_mov_b32 v122, 0
    v_mov_b32 v123, 0
    v_mov_b32 v124, 0
    v_mov_b32 v125, 0
    v_mov_b32 v126, 0
    v_mov_b32 v127, 0
    v_mov_b32 v128, 0
    v_mov_b32 v129, 0
    v_mov_b32 v130, 0
    v_mov_b32 v131, 0
    v_mov_b32 v132, 0
    v_mov_b32 v133, 0
    v_mov_b32 v134, 0
    v_mov_b32 v135, 0
    v_mov_b32 v136, 0
    v_mov_b32 v137, 0
    v_mov_b32 v138, 0
    v_mov_b32 v139, 0
    v_mov_b32 v140, 0
    v_mov_b32 v141, 0
    v_mov_b32 v142, 0
    v_mov_b32 v143, 0
    s_mov_b32 s60, 0x0000ffff
    s_mov_b32 s61, 0x0000ffff
    s_waitcnt vmcnt(9)
    s_branch G_DONE
G_TYPEB:
    s_lshl_b32 s55, s48, 3
    v_add_u32 v26, s55, v24
    v_bfe_u32 v27, v1, 4, 1
    s_mov_b32 s58, 3072
    v_mul_lo_u32 v26, v26, s58
    s_mov_b32 s28, s6
    s_mov_b32 s29, s7
    s_mov_b32 s30, 0x180000
    s_mov_b32 s31, 0x00020000
    s_lshl_b32 s56, s53, 6
    v_lshlrev_b32 v27, 2, v27
    v_xor_b32 v27, v27, v25
    v_lshrrev_b32 v28, 2, v27
    v_and_b32 v27, 3, v27
    v_lshl_add_u32 v8, v27, 4, v26
    v_lshl_add_u32 v8, v28, 10, v8
    v_add_u32 v8, s56, v8
    v_bfe_u32 v26, v1, 2, 3
    v_add_u32 v26, s55, v26
    v_mul_lo_u32 v26, v26, s58
    v_and_b32 v27, 3, v1
    v_lshl_add_u32 v9, v27, 4, v26
    s_add_u32 s56, s56, 2048
    v_add_u32 v9, s56, v9
    s_lshl_b32 s62, s48, 9
    s_add_u32 s62, s62, 40960
    v_lshrrev_b32 v26, 4, v1
    v_and_b32 v27, 15, v1
    v_lshlrev_b32 v27, 4, v27
    v_lshl_add_u32 v246, v26, 10, v27
    s_lshl_b32 s70, s49, 3
    s_add_u32 s70, s70, s52
    s_lshl_b32 s70, s70, 3
    s_add_u32 s70, s70, s48
    s_lshl_b32 s70, s70, 12
    s_and_b32 s71, s49, 3
    s_lshl_b32 s71, s71, 5
    s_lshl_b32 s57, s48, 2
    s_add_u32 s71, s71, s57
    v_mul_lo_u32 v26, v26, s58
    v_and_b32 v27, 15, v1
    v_min_u32 v27, 11, v27
    v_lshrrev_b32 v28, 2, v27
    v_and_b32 v27, 3, v27
    v_lshl_add_u32 v26, v27, 4, v26
    v_lshl_add_u32 v247, v28, 10, v26
    s_mul_i32 s71, s71, s58
    s_lshl_b32 s57, s53, 6
    s_add_u32 s71, s71, s57
    s_add_u32 s65, s3, 0
    s_and_b32 s65, s65, 7
    s_lshl_b32 s67, s65, 7
    s_mul_i32 s65, s65, 196608
    s_add_u32 m0, s61, 0
    s_nop 0
    buffer_load_dwordx4 v8, s[28:31], s65 offen lds
    s_add_u32 m0, s62, 0
    s_mov_b32 exec_hi, 0
    buffer_load_dwordx4 v9, s[28:31], s65 offen lds
    s_mov_b32 exec_hi, -1
    s_mov_b32 s66, 3584
    s_lshr_b32 s55, s48, 2
    s_cmp_eq_u32 s55, 0
    s_cselect_b32 s72, s12, s14
    s_cselect_b32 s73, s13, s15
    s_mov_b32 s74, 0x1c0000
    s_mov_b32 s75, 0x00020000
    s_and_b32 s56, s48, 3
    s_lshl_b32 s57, s3, 2
    s_add_u32 s57, s57, s56
    s_mul_i32 s57, s57, 57344
    s_lshl_b32 s55, s48, 10
    s_add_u32 m0, s55, 147456
    v_lshrrev_b32 v26, 2, v1
    v_mul_lo_u32 v26, v26, s66
    v_and_b32 v27, 3, v1
    v_lshl_add_u32 v26, v27, 4, v26
    s_add_u32 s70, s53, 32
    s_lshl_b32 s70, s70, 6
    s_add_u32 s57, s57, s70
    buffer_load_dwordx4 v26, s[72:75], s57 offen lds
    v_lshrrev_b32 v23, 5, v1
    v_bfe_u32 v26, v1, 2, 2
    v_lshl_add_u32 v23, v23, 2, v26
    v_lshlrev_b32 v23, 6, v23
    v_lshl_add_u32 v23, v27, 3, v23
    v_bfe_u32 v26, v1, 4, 1
    v_lshl_add_u32 v23, v26, 5, v23
    s_add_u32 s55, s55, 147456
    v_add_u32 v23, s55, v23
    v_and_b32 v24, 31, v1
    v_lshrrev_b32 v25, 5, v1
    v_lshlrev_b32 v2, 4, v1
    v_bfe_u32 v26, v1, 1, 3
    v_xor_b32 v26, v26, v25
    v_lshlrev_b32 v27, 7, v24
    v_add_u32 v27, s60, v27
    v_xor_b32 v28, 0, v26
    v_lshl_add_u32 v12, v28, 4, v27
    v_xor_b32 v28, 2, v26
    v_lshl_add_u32 v13, v28, 4, v27
    v_xor_b32 v28, 4, v26
    v_lshl_add_u32 v14, v28, 4, v27
    v_xor_b32 v28, 6, v26
    v_lshl_add_u32 v15, v28, 4, v27
    v_bfe_u32 v24, v1, 4, 1
    v_bfe_u32 v26, v1, 2, 2
    v_and_b32 v27, 3, v1
    v_bfe_u32 v28, v1, 3, 1
    v_lshl_add_u32 v29, v25, 3, v26
    v_lshlrev_b32 v16, 7, v29
    v_lshl_add_u32 v16, v27, 3, v16
    v_lshl_add_u32 v16, v24, 5, v16
    v_lshl_add_u32 v16, v28, 6, v16
    v_add_u32 v16, 32768, v16
    v_xor_b32 v17, 64, v16
    v_lshlrev_b32 v18, 6, v29
    v_lshl_add_u32 v18, v27, 3, v18
    v_lshl_add_u32 v18, v24, 5, v18
    v_add_u32 v18, 40960, v18
    v_mov_b32 v19, 0
    v_lshlrev_b32 v30, 7, v26
    v_lshl_add_u32 v30, v27, 3, v30
    v_lshl_add_u32 v30, v24, 5, v30
    v_xor_b32 v29, v28, v25
    v_lshl_add_u32 v30, v29, 6, v30
    v_add_u32 v30, s61, v30
    v_lshl_add_u32 v29, v25, 2, v26
    v_lshlrev_b32 v31, 6, v29
    v_lshl_add_u32 v31, v27, 3, v31
    v_lshl_add_u32 v31, v24, 5, v31
    v_add_u32 v31, s62, v31
    v_mov_b32 v20, 0
    v_mov_b32 v28, 0
    v_mov_b32 v29, 0
    s_mov_b32 s68, 0x3f803f80
    s_mov_b32 s69, 0xffff0000
    s_mov_b32 s58, 3584
    s_lshr_b32 s55, s48, 2
    s_cmp_eq_u32 s55, 0
    s_cselect_b32 s32, s12, s14
    s_cselect_b32 s33, s13, s15
    s_mov_b32 s34, 0x1c0000
    s_mov_b32 s35, 0x00020000
    s_lshl_b32 s55, s55, 1
    v_and_b32 v27, 3, v1
    v_xor_b32 v27, s55, v27
    v_lshrrev_b32 v26, 2, v1
    s_and_b32 s56, s48, 3
    v_mul_lo_u32 v26, v26, s58
    v_lshl_add_u32 v24, v27, 4, v26
    s_add_u32 s59, s56, s3
    s_and_b32 s59, s59, 7
    s_xor_b32 s63, s59, 4
    s_mul_i32 s59, s59, 229376
    s_mul_i32 s63, s63, 229376
    s_add_u32 s57, s53, 32
    s_lshl_b32 s57, s57, 6
    v_add_u32 v24, s57, v24
    s_waitcnt vmcnt(7)
    v_lshlrev_b32 v228, 16, v224
    v_and_b32 v229, s69, v224
    v_lshlrev_b32 v230, 16, v225
    v_and_b32 v231, s69, v225
    v_lshlrev_b32 v232, 16, v226
    v_and_b32 v233, s69, v226
    v_lshlrev_b32 v234, 16, v227
    v_and_b32 v235, s69, v227
    v_add_f32 v236, v228, v229
    v_add_f32 v237, v230, v231
    v_add_f32 v238, v232, v233
    v_add_f32 v239, v234, v235
    v_add_f32 v236, v236, v237
    v_add_f32 v238, v238, v239
    v_add_f32 v236, v236, v238
    s_nop 1
    v_add_f32_dpp v236, v236, v236 quad_perm:[1,0,3,2] row_mask:0xf bank_mask:0xf
    s_nop 1
    v_add_f32_dpp v236, v236, v236 quad_perm:[2,3,0,1] row_mask:0xf bank_mask:0xf
    s_nop 1
    v_add_f32_dpp v236, v236, v236 row_half_mirror row_mask:0xf bank_mask:0xf
    s_nop 1
    v_add_f32_dpp v236, v236, v236 row_mirror row_mask:0xf bank_mask:0xf
    v_mov_b32 v237, v236
    s_nop 1
    v_permlane16_swap_b32 v236, v237
    s_nop 1
    v_add_f32 v236, v236, v237
    v_mov_b32 v237, v236
    s_nop 1
    v_permlane32_swap_b32 v236, v237
    s_nop 1
    v_add_f32 v236, v236, v237
    v_mul_f32 v236, 0xbb000000, v236
    v_add_f32 v228, v228, v236
    v_add_f32 v229, v229, v236
    v_add_f32 v230, v230, v236
    v_add_f32 v231, v231, v236
    v_add_f32 v232, v232, v236
    v_add_f32 v233, v233, v236
    v_add_f32 v234, v234, v236
    v_add_f32 v235, v235, v236
    v_mul_f32 v238, v228, v228
    v_mul_f32 v239, v229, v229
    v_fmac_f32 v238, v230, v230
    v_fmac_f32 v239, v231, v231
    v_fmac_f32 v238, v232, v232
    v_fmac_f32 v239, v233, v233
    v_fmac_f32 v238, v234, v234
    v_fmac_f32 v239, v235, v235
    v_add_f32 v238, v238, v239
    s_nop 1
    v_add_f32_dpp v238, v238, v238 quad_perm:[1,0,3,2] row_mask:0xf bank_mask:0xf
    s_nop 1
    v_add_f32_dpp v238, v238, v238 quad_perm:[2,3,0,1] row_mask:0xf bank_mask:0xf
    s_nop 1
    v_add_f32_dpp v238, v238, v238 row_half_mirror row_mask:0xf bank_mask:0xf
    s_nop 1
    v_add_f32_dpp v238, v238, v238 row_mirror row_mask:0xf bank_mask:0xf
    v_mov_b32 v237, v238
    s_nop 1
    v_permlane16_swap_b32 v238, v237
    s_nop 1
    v_add_f32 v238, v238, v237
    v_mov_b32 v237, v238
    s_nop 1
    v_permlane32_swap_b32 v238, v237
    s_nop 1
    v_add_f32 v238, v238, v237
    v_mul_f32 v238, 0x3b000000, v238
    v_cvt_pk_bf16_f32 v238, v238, v238
    v_and_b32 v238, s69, v238
    v_add_f32 v238, 0x3727c5ac, v238
    v_cvt_pk_bf16_f32 v238, v238, v238
    v_and_b32 v238, s69, v238
    v_sqrt_f32 v238, v238
    v_cvt_pk_bf16_f32 v236, v236, v236
    v_cvt_pk_bf16_f32 v238, v238, v238
    v_and_b32 v238, s69, v238
    v_rcp_f32 v237, v238
    s_lshl_b32 s55, s48, 3
    s_add_u32 s55, s55, 161408
    v_mov_b32 v239, s55
    ds_write_b64 v239, v[236:237]
    s_add_u32 s65, s3, 1
    s_and_b32 s65, s65, 7
    s_lshl_b32 s67, s65, 7
    s_mul_i32 s65, s65, 196608
    s_add_u32 m0, s61, 49152
    s_nop 0
    buffer_load_dwordx4 v8, s[28:31], s65 offen lds
    s_add_u32 m0, s62, 49152
    s_mov_b32 exec_hi, 0
    buffer_load_dwordx4 v9, s[28:31], s65 offen lds
    s_mov_b32 exec_hi, -1
    s_add_u32 m0, s60, 49152
    s_mov_b32 s64, s67
    buffer_load_dwordx4 v4, s[24:27], s64 offen offset:0 lds
    buffer_load_dwordx4 v5, s[24:27], s64 offen offset:1024 lds
    buffer_load_dwordx4 v6, s[24:27], s64 offen offset:2048 lds
    buffer_load_dwordx4 v7, s[24:27], s64 offen offset:3072 lds
    s_waitcnt vmcnt(6)
    s_waitcnt lgkmcnt(0)
    s_barrier
    ds_read_b64_tr_b16 v[48:49], v30 offset:0
    ds_read_b64_tr_b16 v[50:51], v30 offset:512
    ds_read_b64_tr_b16 v[52:53], v31 offset:0
    ds_read_b64_tr_b16 v[56:57], v23
    ds_read_b64_tr_b16 v[58:59], v23 offset:512
    ds_read_b128 v[128:131], v12 offset:0
    ds_read_b64_tr_b16 v[32:33], v16 offset:0
    ds_read_b64_tr_b16 v[34:35], v16 offset:512
    ds_read_b64_tr_b16 v[36:37], v17 offset:0
    ds_read_b64_tr_b16 v[38:39], v17 offset:512
    ds_read_b64_tr_b16 v[40:41], v18 offset:0
    ds_read_b64_tr_b16 v[42:43], v18 offset:256
    s_cmp_lg_u32 s48, 0
    s_cbranch_scc1 GB_NONL
    buffer_load_dword v0, off, s[44:47], 0 sc1
GB_NONL:
    s_waitcnt lgkmcnt(7)
    v_dot2c_f32_bf16 v28, s68, v48
    v_dot2c_f32_bf16 v29, s68, v52
    v_dot2c_f32_bf16 v20, s68, v56
    v_dot2c_f32_bf16 v28, s68, v49
    v_dot2c_f32_bf16 v29, s68, v53
    v_dot2c_f32_bf16 v20, s68, v57
    v_dot2c_f32_bf16 v28, s68, v50
    v_dot2c_f32_bf16 v20, s68, v58
    v_dot2c_f32_bf16 v28, s68, v51
    v_dot2c_f32_bf16 v20, s68, v59
    s_lshl_b32 s55, s48, 2
    s_add_u32 s55, s55, 155648
    v_lshlrev_b32 v26, 1, v2
    v_add_u32 v26, s55, v26
    ds_write_b32 v26, v28
    v_and_b32 v27, 15, v1
    v_lshlrev_b32 v27, 5, v27
    s_lshr_b32 s55, s48, 2
    s_lshl_b32 s55, s55, 9
    s_lshl_b32 s57, s56, 3
    s_add_u32 s55, s55, s57
    v_mov_b32 v3, v29
    v_and_b32 v26, 0x3ff, v26
    v_add_u32 v26, 157696, v26
    v_permlane32_swap_b32 v29, v3
    s_add_u32 s55, s55, 158720
    v_add_u32 v27, s55, v27
    v_add_f32 v3, v3, v29
    ds_write_b32 v26, v3
    v_bfe_u32 v26, v1, 4, 1
    v_lshl_add_u32 v27, v26, 10, v27
    v_lshrrev_b32 v26, 5, v1
    v_lshl_add_u32 v27, v26, 2, v27
    ds_write_b32 v27, v20
    s_waitcnt lgkmcnt(0)
    s_waitcnt lgkmcnt(4)
    v_mfma_f32_32x32x16_bf16 v[64:79], v[32:35], v[128:131], 0
    ds_read_b128 v[132:135], v13 offset:0
    ds_read_b64_tr_b16 v[48:49], v16 offset:2048
    ds_read_b64_tr_b16 v[50:51], v16 offset:2560
    s_add_u32 s65, s3, 2
    s_and_b32 s65, s65, 7
    s_lshl_b32 s67, s65, 7
    s_mul_i32 s65, s65, 196608
    s_add_u32 m0, s61, 98304
    s_nop 0
    buffer_load_dwordx4 v8, s[28:31], s65 offen lds
    s_waitcnt lgkmcnt(5)
    v_mfma_f32_32x32x16_bf16 v[80:95], v[36:39], v[128:131], 0
    ds_read_b64_tr_b16 v[52:53], v17 offset:2048
    ds_read_b64_tr_b16 v[54:55], v17 offset:2560
    s_waitcnt lgkmcnt(5)
    v_mfma_f32_32x32x16_bf16 v[96:111], v[128:131], v[40:43], 0
    ds_read_b64_tr_b16 v[56:57], v18 offset:1024
    ds_read_b64_tr_b16 v[58:59], v18 offset:1280
    s_add_u32 m0, s62, 98304
    s_mov_b32 exec_hi, 0
    buffer_load_dwordx4 v9, s[28:31], s65 offen lds
    s_mov_b32 exec_hi, -1
    s_waitcnt lgkmcnt(4)
    v_mfma_f32_32x32x16_bf16 v[64:79], v[48:51], v[132:135], v[64:79]
    ds_read_b128 v[136:139], v14 offset:0
    ds_read_b64_tr_b16 v[32:33], v16 offset:4096
    ds_read_b64_tr_b16 v[34:35], v16 offset:4608
    s_add_u32 m0, s60, 98304
    s_mov_b32 s64, s67
    buffer_load_dwordx4 v4, s[24:27], s64 offen offset:0 lds
    s_waitcnt lgkmcnt(5)
    v_mfma_f32_32x32x16_bf16 v[80:95], v[52:55], v[132:135], v[80:95]
    ds_read_b64_tr_b16 v[36:37], v17 offset:4096
    ds_read_b64_tr_b16 v[38:39], v17 offset:4608
    s_waitcnt lgkmcnt(5)
    v_mfma_f32_32x32x16_bf16 v[96:111], v[132:135], v[56:59], v[96:111]
    ds_read_b64_tr_b16 v[40:41], v18 offset:2048
    ds_read_b64_tr_b16 v[42:43], v18 offset:2304
    buffer_load_dwordx4 v5, s[24:27], s64 offen offset:1024 lds
    s_waitcnt lgkmcnt(4)
    v_mfma_f32_32x32x16_bf16 v[64:79], v[32:35], v[136:139], v[64:79]
    ds_read_b128 v[140:143], v15 offset:0
    ds_read_b64_tr_b16 v[48:49], v16 offset:6144
    ds_read_b64_tr_b16 v[50:51], v16 offset:6656
    buffer_load_dwordx4 v6, s[24:27], s64 offen offset:2048 lds
    s_waitcnt lgkmcnt(5)
    v_mfma_f32_32x32x16_bf16 v[80:95], v[36:39], v[136:139], v[80:95]
    ds_read_b64_tr_b16 v[52:53], v17 offset:6144
    ds_read_b64_tr_b16 v[54:55], v17 offset:6656
    s_waitcnt lgkmcnt(5)
    v_mfma_f32_32x32x16_bf16 v[96:111], v[136:139], v[40:43], v[96:111]
    ds_read_b64_tr_b16 v[56:57], v18 offset:3072
    ds_read_b64_tr_b16 v[58:59], v18 offset:3328
    buffer_load_dwordx4 v7, s[24:27], s64 offen offset:3072 lds
    s_waitcnt lgkmcnt(4)
    v_mfma_f32_32x32x16_bf16 v[64:79], v[48:51], v[140:143], v[64:79]
    s_waitcnt lgkmcnt(2)
    v_mfma_f32_32x32x16_bf16 v[80:95], v[52:55], v[140:143], v[80:95]
    s_waitcnt lgkmcnt(0)
    v_mfma_f32_32x32x16_bf16 v[96:111], v[140:143], v[56:59], v[96:111]
    s_waitcnt vmcnt(6)
    s_waitcnt lgkmcnt(0)
    s_barrier
    s_cmp_ge_u32 s48, 3
    s_cbranch_scc1 GB_NORED
    s_lshl_b32 s55, s48, 6
    v_add_u32 v26, s55, v1
    v_min_u32 v27, 159, v26
    v_lshlrev_b32 v27, 5, v27
    v_add_u32 v27, 155648, v27
    ds_read_b128 v[48:51], v27
    ds_read_b128 v[52:55], v27 offset:16
    v_cmp_lt_u32 vcc, 159, v26
    v_lshlrev_b32 v26, 2, v26
    v_add_u32 v27, 160768, v26
    ds_read_b32 v56, v27
    s_sub_u32 s55, s36, 23068672
    s_lshl_b32 s55, s55, 3
    s_add_u32 s55, s55, 23592960
    s_waitcnt lgkmcnt(0)
    v_add_f32 v48, v48, v52
    v_add_f32 v49, v49, v53
    v_add_f32 v50, v50, v54
    v_add_f32 v51, v51, v55
    v_add_f32 v48, v48, v49
    v_add_f32 v50, v50, v51
    v_add_f32 v48, v48, v50
    v_cndmask_b32 v20, v48, v56, vcc
    buffer_store_dword v20, v26, s[40:43], s55 offen sc1
GB_NORED:
    ds_read_b128 v[144:147], v12 offset:49152
    ds_read_b64_tr_b16 v[32:33], v16 offset:49152
    ds_read_b64_tr_b16 v[34:35], v16 offset:49664
    ds_read_b64_tr_b16 v[36:37], v17 offset:49152
    ds_read_b64_tr_b16 v[38:39], v17 offset:49664
    ds_read_b64_tr_b16 v[40:41], v18 offset:49152
    ds_read_b64_tr_b16 v[42:43], v18 offset:49408
    s_waitcnt lgkmcnt(4)
    v_mfma_f32_32x32x16_bf16 v[64:79], v[32:35], v[144:147], v[64:79]
    ds_read_b128 v[148:151], v13 offset:49152
    ds_read_b64_tr_b16 v[48:49], v16 offset:51200
    ds_read_b64_tr_b16 v[50:51], v16 offset:51712
    s_add_u32 s65, s3, 3
    s_and_b32 s65, s65, 7
    s_lshl_b32 s67, s65, 7
    s_mul_i32 s65, s65, 196608
    s_add_u32 m0, s61, 0
    s_nop 0
    buffer_load_dwordx4 v8, s[28:31], s65 offen lds
    s_waitcnt lgkmcnt(5)
    v_mfma_f32_32x32x16_bf16 v[80:95], v[36:39], v[144:147], v[80:95]
    ds_read_b64_tr_b16 v[52:53], v17 offset:51200
    ds_read_b64_tr_b16 v[54:55], v17 offset:51712
    s_waitcnt lgkmcnt(5)
    v_mfma_f32_32x32x16_bf16 v[96:111], v[144:147], v[40:43], v[96:111]
    ds_read_b64_tr_b16 v[56:57], v18 offset:50176
    ds_read_b64_tr_b16 v[58:59], v18 offset:50432
    s_add_u32 m0, s62, 0
    s_mov_b32 exec_hi, 0
    buffer_load_dwordx4 v9, s[28:31], s65 offen lds
    s_mov_b32 exec_hi, -1
    s_waitcnt lgkmcnt(4)
    v_mfma_f32_32x32x16_bf16 v[64:79], v[48:51], v[148:151], v[64:79]
    ds_read_b128 v[152:155], v14 offset:49152
    ds_read_b64_tr_b16 v[32:33], v16 offset:53248
    ds_read_b64_tr_b16 v[34:35], v16 offset:53760
    s_add_u32 m0, s60, 0
    s_mov_b32 s64, s67
    buffer_load_dwordx4 v4, s[24:27], s64 offen offset:0 lds
    s_waitcnt lgkmcnt(5)
    v_mfma_f32_32x32x16_bf16 v[80:95], v[52:55], v[148:151], v[80:95]
    ds_read_b64_tr_b16 v[36:37], v17 offset:53248
    ds_read_b64_tr_b16 v[38:39], v17 offset:53760
    s_waitcnt lgkmcnt(5)
    v_mfma_f32_32x32x16_bf16 v[96:111], v[148:151], v[56:59], v[96:111]
    ds_read_b64_tr_b16 v[40:41], v18 offset:51200
    ds_read_b64_tr_b16 v[42:43], v18 offset:51456
    buffer_load_dwordx4 v5, s[24:27], s64 offen offset:1024 lds
    s_waitcnt lgkmcnt(4)
    v_mfma_f32_32x32x16_bf16 v[64:79], v[32:35], v[152:155], v[64:79]
    ds_read_b128 v[156:159], v15 offset:49152
    ds_read_b64_tr_b16 v[48:49], v16 offset:55296
    ds_read_b64_tr_b16 v[50:51], v16 offset:55808
    buffer_load_dwordx4 v6, s[24:27], s64 offen offset:2048 lds
    s_waitcnt lgkmcnt(5)
    v_mfma_f32_32x32x16_bf16 v[80:95], v[36:39], v[152:155], v[80:95]
    ds_read_b64_tr_b16 v[52:53], v17 offset:55296
    ds_read_b64_tr_b16 v[54:55], v17 offset:55808
    s_waitcnt lgkmcnt(5)
    v_mfma_f32_32x32x16_bf16 v[96:111], v[152:155], v[40:43], v[96:111]
    ds_read_b64_tr_b16 v[56:57], v18 offset:52224
    ds_read_b64_tr_b16 v[58:59], v18 offset:52480
    buffer_load_dwordx4 v7, s[24:27], s64 offen offset:3072 lds
    s_waitcnt lgkmcnt(4)
    v_mfma_f32_32x32x16_bf16 v[64:79], v[48:51], v[156:159], v[64:79]
    s_and_b32 s55, s49, 3
    s_mul_i32 s55, s55, 57344
    s_add_u32 s57, s55, s59
    buffer_load_dwordx4 v[252:255], v24, s[32:35], s57 offen
    s_waitcnt lgkmcnt(2)
    v_mfma_f32_32x32x16_bf16 v[80:95], v[52:55], v[156:159], v[80:95]
    s_waitcnt lgkmcnt(0)
    v_mfma_f32_32x32x16_bf16 v[96:111], v[156:159], v[56:59], v[96:111]
    s_add_u32 s57, s55, s63
    buffer_load_dwordx4 v[248:251], v24, s[32:35], s57 offen
    v_add_u32 v12, 98304, v12
    v_add_u32 v13, 98304, v13
    v_add_u32 v14, 98304, v14
    v_add_u32 v15, 98304, v15
    v_add_u32 v16, 98304, v16
    v_add_u32 v17, 98304, v17
    v_add_u32 v18, 98304, v18
    s_waitcnt vmcnt(8)
    s_waitcnt lgkmcnt(0)
    s_barrier
    ds_read_b128 v[160:163], v12 offset:0
    ds_read_b64_tr_b16 v[32:33], v16 offset:0
    ds_read_b64_tr_b16 v[34:35], v16 offset:512
    ds_read_b64_tr_b16 v[36:37], v17 offset:0
    ds_read_b64_tr_b16 v[38:39], v17 offset:512
    ds_read_b64_tr_b16 v[40:41], v18 offset:0
    ds_read_b64_tr_b16 v[42:43], v18 offset:256
    s_waitcnt lgkmcnt(4)
    v_mfma_f32_32x32x16_bf16 v[64:79], v[32:35], v[160:163], v[64:79]
    ds_read_b128 v[164:167], v13 offset:0
    ds_read_b64_tr_b16 v[48:49], v16 offset:2048
    ds_read_b64_tr_b16 v[50:51], v16 offset:2560
    s_add_u32 s65, s3, 4
    s_and_b32 s65, s65, 7
    s_lshl_b32 s67, s65, 7
    s_mul_i32 s65, s65, 196608
    s_add_u32 m0, s61, 49152
    s_nop 0
    buffer_load_dwordx4 v8, s[28:31], s65 offen lds
    s_waitcnt lgkmcnt(5)
    v_mfma_f32_32x32x16_bf16 v[80:95], v[36:39], v[160:163], v[80:95]
    ds_read_b64_tr_b16 v[52:53], v17 offset:2048
    ds_read_b64_tr_b16 v[54:55], v17 offset:2560
    s_waitcnt lgkmcnt(5)
    v_mfma_f32_32x32x16_bf16 v[96:111], v[160:163], v[40:43], v[96:111]
    ds_read_b64_tr_b16 v[56:57], v18 offset:1024
    ds_read_b64_tr_b16 v[58:59], v18 offset:1280
    s_add_u32 m0, s62, 49152
    s_mov_b32 exec_hi, 0
    buffer_load_dwordx4 v9, s[28:31], s65 offen lds
    s_mov_b32 exec_hi, -1
    s_waitcnt lgkmcnt(4)
    v_mfma_f32_32x32x16_bf16 v[64:79], v[48:51], v[164:167], v[64:79]
    ds_read_b128 v[168:171], v14 offset:0
    ds_read_b64_tr_b16 v[32:33], v16 offset:4096
    ds_read_b64_tr_b16 v[34:35], v16 offset:4608
    s_add_u32 m0, s60, 49152
    s_mov_b32 s64, s67
    buffer_load_dwordx4 v4, s[24:27], s64 offen offset:0 lds
    s_waitcnt lgkmcnt(5)
    v_mfma_f32_32x32x16_bf16 v[80:95], v[52:55], v[164:167], v[80:95]
    ds_read_b64_tr_b16 v[36:37], v17 offset:4096
    ds_read_b64_tr_b16 v[38:39], v17 offset:4608
    s_waitcnt lgkmcnt(5)
    v_mfma_f32_32x32x16_bf16 v[96:111], v[164:167], v[56:59], v[96:111]
    ds_read_b64_tr_b16 v[40:41], v18 offset:2048
    ds_read_b64_tr_b16 v[42:43], v18 offset:2304
    buffer_load_dwordx4 v5, s[24:27], s64 offen offset:1024 lds
    s_waitcnt lgkmcnt(4)
    v_mfma_f32_32x32x16_bf16 v[64:79], v[32:35], v[168:171], v[64:79]
    ds_read_b128 v[172:175], v15 offset:0
    ds_read_b64_tr_b16 v[48:49], v16 offset:6144
    ds_read_b64_tr_b16 v[50:51], v16 offset:6656
    buffer_load_dwordx4 v6, s[24:27], s64 offen offset:2048 lds
    s_waitcnt lgkmcnt(5)
    v_mfma_f32_32x32x16_bf16 v[80:95], v[36:39], v[168:171], v[80:95]
    ds_read_b64_tr_b16 v[52:53], v17 offset:6144
    ds_read_b64_tr_b16 v[54:55], v17 offset:6656
    s_waitcnt lgkmcnt(5)
    v_mfma_f32_32x32x16_bf16 v[96:111], v[168:171], v[40:43], v[96:111]
    ds_read_b64_tr_b16 v[56:57], v18 offset:3072
    ds_read_b64_tr_b16 v[58:59], v18 offset:3328
    buffer_load_dwordx4 v7, s[24:27], s64 offen offset:3072 lds
    s_waitcnt lgkmcnt(4)
    v_mfma_f32_32x32x16_bf16 v[64:79], v[48:51], v[172:175], v[64:79]
    s_waitcnt lgkmcnt(2)
    v_mfma_f32_32x32x16_bf16 v[80:95], v[52:55], v[172:175], v[80:95]
    s_waitcnt lgkmcnt(0)
    v_mfma_f32_32x32x16_bf16 v[96:111], v[172:175], v[56:59], v[96:111]
    v_subrev_u32 v12, 98304, v12
    v_subrev_u32 v13, 98304, v13
    v_subrev_u32 v14, 98304, v14
    v_subrev_u32 v15, 98304, v15
    v_subrev_u32 v16, 98304, v16
    v_subrev_u32 v17, 98304, v17
    v_subrev_u32 v18, 98304, v18
    s_waitcnt vmcnt(8)
    s_barrier
    s_cmp_lg_u32 s48, 0
    s_cbranch_scc1 GB_NOREC
    s_mov_b32 s37, 262144
GB_NCHK:
    v_readfirstlane_b32 s39, v0
    s_cmp_lg_u32 s39, 0
    s_cbranch_scc1 GB_NOK
    s_sub_u32 s37, s37, 1
    s_cmp_eq_u32 s37, 0
    s_cbranch_scc1 GB_NOK
    s_sleep 4
    buffer_load_dword v0, off, s[44:47], 0 sc1
    s_waitcnt vmcnt(0)
    s_branch GB_NCHK
GB_NOK:
    s_and_b32 s39, s39, -8
GB_NOREC:
    s_cmp_lg_u32 s48, 0
    s_cbranch_scc1 GB_FL1
    s_add_u32 s37, s39, 1
    v_mov_b32 v0, s37
    s_mov_b32 exec_hi, 0
    buffer_store_dword v0, v11, s[40:43], s36 offen sc1
    s_mov_b32 exec_hi, -1
GB_FL1:
    ds_read_b128 v[176:179], v12 offset:0
    ds_read_b64_tr_b16 v[32:33], v16 offset:0
    ds_read_b64_tr_b16 v[34:35], v16 offset:512
    ds_read_b64_tr_b16 v[36:37], v17 offset:0
    ds_read_b64_tr_b16 v[38:39], v17 offset:512
    ds_read_b64_tr_b16 v[40:41], v18 offset:0
    ds_read_b64_tr_b16 v[42:43], v18 offset:256
    s_waitcnt lgkmcnt(4)
    v_mfma_f32_32x32x16_bf16 v[64:79], v[32:35], v[176:179], v[64:79]
    ds_read_b128 v[180:183], v13 offset:0
    ds_read_b64_tr_b16 v[48:49], v16 offset:2048
    ds_read_b64_tr_b16 v[50:51], v16 offset:2560
    s_add_u32 s65, s3, 5
    s_and_b32 s65, s65, 7
    s_lshl_b32 s67, s65, 7
    s_mul_i32 s65, s65, 196608
    s_add_u32 m0, s61, 98304
    s_nop 0
    buffer_load_dwordx4 v8, s[28:31], s65 offen lds
    s_waitcnt lgkmcnt(5)
    v_mfma_f32_32x32x16_bf16 v[80:95], v[36:39], v[176:179], v[80:95]
    ds_read_b64_tr_b16 v[52:53], v17 offset:2048
    ds_read_b64_tr_b16 v[54:55], v17 offset:2560
    s_waitcnt lgkmcnt(5)
    v_mfma_f32_32x32x16_bf16 v[96:111], v[176:179], v[40:43], v[96:111]
    ds_read_b64_tr_b16 v[56:57], v18 offset:1024
    ds_read_b64_tr_b16 v[58:59], v18 offset:1280
    s_add_u32 m0, s62, 98304
    s_mov_b32 exec_hi, 0
    buffer_load_dwordx4 v9, s[28:31], s65 offen lds
    s_mov_b32 exec_hi, -1
    s_waitcnt lgkmcnt(4)
    v_mfma_f32_32x32x16_bf16 v[64:79], v[48:51], v[180:183], v[64:79]
    ds_read_b128 v[184:187], v14 offset:0
    ds_read_b64_tr_b16 v[32:33], v16 offset:4096
    ds_read_b64_tr_b16 v[34:35], v16 offset:4608
    s_add_u32 m0, s60, 98304
    s_mov_b32 s64, s67
    buffer_load_dwordx4 v4, s[24:27], s64 offen offset:0 lds
    s_waitcnt lgkmcnt(5)
    v_mfma_f32_32x32x16_bf16 v[80:95], v[52:55], v[180:183], v[80:95]
    ds_read_b64_tr_b16 v[36:37], v17 offset:4096
    ds_read_b64_tr_b16 v[38:39], v17 offset:4608
    s_waitcnt lgkmcnt(5)
    v_mfma_f32_32x32x16_bf16 v[96:111], v[180:183], v[56:59], v[96:111]
    ds_read_b64_tr_b16 v[40:41], v18 offset:2048
    ds_read_b64_tr_b16 v[42:43], v18 offset:2304
    buffer_load_dwordx4 v5, s[24:27], s64 offen offset:1024 lds
    s_waitcnt lgkmcnt(4)
    v_mfma_f32_32x32x16_bf16 v[64:79], v[32:35], v[184:187], v[64:79]
    ds_read_b128 v[188:191], v15 offset:0
    ds_read_b64_tr_b16 v[48:49], v16 offset:6144
    ds_read_b64_tr_b16 v[50:51], v16 offset:6656
    buffer_load_dwordx4 v6, s[24:27], s64 offen offset:2048 lds
    s_waitcnt lgkmcnt(5)
    v_mfma_f32_32x32x16_bf16 v[80:95], v[36:39], v[184:187], v[80:95]
    ds_read_b64_tr_b16 v[52:53], v17 offset:6144
    ds_read_b64_tr_b16 v[54:55], v17 offset:6656
    s_waitcnt lgkmcnt(5)
    v_mfma_f32_32x32x16_bf16 v[96:111], v[184:187], v[40:43], v[96:111]
    ds_read_b64_tr_b16 v[56:57], v18 offset:3072
    ds_read_b64_tr_b16 v[58:59], v18 offset:3328
    buffer_load_dwordx4 v7, s[24:27], s64 offen offset:3072 lds
    s_waitcnt lgkmcnt(4)
    v_mfma_f32_32x32x16_bf16 v[64:79], v[48:51], v[188:191], v[64:79]
    s_waitcnt lgkmcnt(2)
    v_mfma_f32_32x32x16_bf16 v[80:95], v[52:55], v[188:191], v[80:95]
    s_waitcnt lgkmcnt(0)
    v_mfma_f32_32x32x16_bf16 v[96:111], v[188:191], v[56:59], v[96:111]
    s_waitcnt vmcnt(6)
    s_barrier
    ds_read_b128 v[192:195], v12 offset:49152
    ds_read_b64_tr_b16 v[32:33], v16 offset:49152
    ds_read_b64_tr_b16 v[34:35], v16 offset:49664
    ds_read_b64_tr_b16 v[36:37], v17 offset:49152
    ds_read_b64_tr_b16 v[38:39], v17 offset:49664
    ds_read_b64_tr_b16 v[40:41], v18 offset:49152
    ds_read_b64_tr_b16 v[42:43], v18 offset:49408
    s_waitcnt lgkmcnt(4)
    v_mfma_f32_32x32x16_bf16 v[64:79], v[32:35], v[192:195], v[64:79]
    ds_read_b128 v[196:199], v13 offset:49152
    ds_read_b64_tr_b16 v[48:49], v16 offset:51200
    ds_read_b64_tr_b16 v[50:51], v16 offset:51712
    s_add_u32 s65, s3, 6
    s_and_b32 s65, s65, 7
    s_lshl_b32 s67, s65, 7
    s_mul_i32 s65, s65, 196608
    s_add_u32 m0, s61, 0
    s_nop 0
    buffer_load_dwordx4 v8, s[28:31], s65 offen lds
    s_waitcnt lgkmcnt(5)
    v_mfma_f32_32x32x16_bf16 v[80:95], v[36:39], v[192:195], v[80:95]
    ds_read_b64_tr_b16 v[52:53], v17 offset:51200
    ds_read_b64_tr_b16 v[54:55], v17 offset:51712
    s_waitcnt lgkmcnt(5)
    v_mfma_f32_32x32x16_bf16 v[96:111], v[192:195], v[40:43], v[96:111]
    ds_read_b64_tr_b16 v[56:57], v18 offset:50176
    ds_read_b64_tr_b16 v[58:59], v18 offset:50432
    s_add_u32 m0, s62, 0
    s_mov_b32 exec_hi, 0
    buffer_load_dwordx4 v9, s[28:31], s65 offen lds
    s_mov_b32 exec_hi, -1
    s_waitcnt lgkmcnt(4)
    v_mfma_f32_32x32x16_bf16 v[64:79], v[48:51], v[196:199], v[64:79]
    ds_read_b128 v[200:203], v14 offset:49152
    ds_read_b64_tr_b16 v[32:33], v16 offset:53248
    ds_read_b64_tr_b16 v[34:35], v16 offset:53760
    s_add_u32 m0, s60, 0
    s_mov_b32 s64, s67
    buffer_load_dwordx4 v4, s[24:27], s64 offen offset:0 lds
    s_waitcnt lgkmcnt(5)
    v_mfma_f32_32x32x16_bf16 v[80:95], v[52:55], v[196:199], v[80:95]
    ds_read_b64_tr_b16 v[36:37], v17 offset:53248
    ds_read_b64_tr_b16 v[38:39], v17 offset:53760
    s_waitcnt lgkmcnt(5)
    v_mfma_f32_32x32x16_bf16 v[96:111], v[196:199], v[56:59], v[96:111]
    ds_read_b64_tr_b16 v[40:41], v18 offset:51200
    ds_read_b64_tr_b16 v[42:43], v18 offset:51456
    buffer_load_dwordx4 v5, s[24:27], s64 offen offset:1024 lds
    s_waitcnt lgkmcnt(4)
    v_mfma_f32_32x32x16_bf16 v[64:79], v[32:35], v[200:203], v[64:79]
    ds_read_b128 v[204:207], v15 offset:49152
    ds_read_b64_tr_b16 v[48:49], v16 offset:55296
    ds_read_b64_tr_b16 v[50:51], v16 offset:55808
    buffer_load_dwordx4 v6, s[24:27], s64 offen offset:2048 lds
    s_waitcnt lgkmcnt(5)
    v_mfma_f32_32x32x16_bf16 v[80:95], v[36:39], v[200:203], v[80:95]
    ds_read_b64_tr_b16 v[52:53], v17 offset:55296
    ds_read_b64_tr_b16 v[54:55], v17 offset:55808
    s_waitcnt lgkmcnt(5)
    v_mfma_f32_32x32x16_bf16 v[96:111], v[200:203], v[40:43], v[96:111]
    ds_read_b64_tr_b16 v[56:57], v18 offset:52224
    ds_read_b64_tr_b16 v[58:59], v18 offset:52480
    buffer_load_dwordx4 v7, s[24:27], s64 offen offset:3072 lds
    s_waitcnt lgkmcnt(4)
    v_mfma_f32_32x32x16_bf16 v[64:79], v[48:51], v[204:207], v[64:79]
    s_waitcnt lgkmcnt(2)
    v_mfma_f32_32x32x16_bf16 v[80:95], v[52:55], v[204:207], v[80:95]
    s_waitcnt lgkmcnt(0)
    v_mfma_f32_32x32x16_bf16 v[96:111], v[204:207], v[56:59], v[96:111]
    v_add_u32 v12, 98304, v12
    v_add_u32 v13, 98304, v13
    v_add_u32 v14, 98304, v14
    v_add_u32 v15, 98304, v15
    v_add_u32 v16, 98304, v16
    v_add_u32 v17, 98304, v17
    v_add_u32 v18, 98304, v18
    s_waitcnt vmcnt(6)
    s_barrier
    s_cmp_lg_u32 s48, 0
    s_cbranch_scc1 GB_NOP1
    v_lshlrev_b32 v28, 3, v1
    v_add_u32 v28, s49, v28
    s_lshl_b32 s55, s50, 3
    v_and_b32 v29, 7, v1
    v_add_u32 v29, s55, v29
    v_cmp_lt_u32 vcc, 31, v1
    s_nop 1
    v_cndmask_b32 v28, v28, v29, vcc
    v_lshlrev_b32 v28, 7, v28
    v_add_u32 v28, 23068672, v28
    buffer_load_dword v29, v28, s[40:43], 0 offen sc1
GB_NOP1:
    ds_read_b128 v[208:211], v12 offset:0
    ds_read_b64_tr_b16 v[32:33], v16 offset:0
    ds_read_b64_tr_b16 v[34:35], v16 offset:512
    ds_read_b64_tr_b16 v[36:37], v17 offset:0
    ds_read_b64_tr_b16 v[38:39], v17 offset:512
    ds_read_b64_tr_b16 v[40:41], v18 offset:0
    ds_read_b64_tr_b16 v[42:43], v18 offset:256
    s_waitcnt lgkmcnt(4)
    v_mfma_f32_32x32x16_bf16 v[64:79], v[32:35], v[208:211], v[64:79]
    ds_read_b128 v[212:215], v13 offset:0
    ds_read_b64_tr_b16 v[48:49], v16 offset:2048
    ds_read_b64_tr_b16 v[50:51], v16 offset:2560
    s_add_u32 s65, s3, 7
    s_and_b32 s65, s65, 7
    s_lshl_b32 s67, s65, 7
    s_mul_i32 s65, s65, 196608
    s_add_u32 m0, s61, 49152
    s_nop 0
    buffer_load_dwordx4 v8, s[28:31], s65 offen lds
    s_waitcnt lgkmcnt(5)
    v_mfma_f32_32x32x16_bf16 v[80:95], v[36:39], v[208:211], v[80:95]
    ds_read_b64_tr_b16 v[52:53], v17 offset:2048
    ds_read_b64_tr_b16 v[54:55], v17 offset:2560
    s_waitcnt lgkmcnt(5)
    v_mfma_f32_32x32x16_bf16 v[96:111], v[208:211], v[40:43], v[96:111]
    ds_read_b64_tr_b16 v[56:57], v18 offset:1024
    ds_read_b64_tr_b16 v[58:59], v18 offset:1280
    s_add_u32 m0, s62, 49152
    s_mov_b32 exec_hi, 0
    buffer_load_dwordx4 v9, s[28:31], s65 offen lds
    s_mov_b32 exec_hi, -1
    s_waitcnt lgkmcnt(4)
    v_mfma_f32_32x32x16_bf16 v[64:79], v[48:51], v[212:215], v[64:79]
    ds_read_b128 v[216:219], v14 offset:0
    ds_read_b64_tr_b16 v[32:33], v16 offset:4096
    ds_read_b64_tr_b16 v[34:35], v16 offset:4608
    s_add_u32 m0, s60, 49152
    s_mov_b32 s64, s67
    buffer_load_dwordx4 v4, s[24:27], s64 offen offset:0 lds
    s_waitcnt lgkmcnt(5)
    v_mfma_f32_32x32x16_bf16 v[80:95], v[52:55], v[212:215], v[80:95]
    ds_read_b64_tr_b16 v[36:37], v17 offset:4096
    ds_read_b64_tr_b16 v[38:39], v17 offset:4608
    s_waitcnt lgkmcnt(5)
    v_mfma_f32_32x32x16_bf16 v[96:111], v[212:215], v[56:59], v[96:111]
    ds_read_b64_tr_b16 v[40:41], v18 offset:2048
    ds_read_b64_tr_b16 v[42:43], v18 offset:2304
    buffer_load_dwordx4 v5, s[24:27], s64 offen offset:1024 lds
    s_waitcnt lgkmcnt(4)
    v_mfma_f32_32x32x16_bf16 v[64:79], v[32:35], v[216:219], v[64:79]
    ds_read_b128 v[220:223], v15 offset:0
    ds_read_b64_tr_b16 v[48:49], v16 offset:6144
    ds_read_b64_tr_b16 v[50:51], v16 offset:6656
    buffer_load_dwordx4 v6, s[24:27], s64 offen offset:2048 lds
    s_waitcnt lgkmcnt(5)
    v_mfma_f32_32x32x16_bf16 v[80:95], v[36:39], v[216:219], v[80:95]
    ds_read_b64_tr_b16 v[52:53], v17 offset:6144
    ds_read_b64_tr_b16 v[54:55], v17 offset:6656
    s_waitcnt lgkmcnt(5)
    v_mfma_f32_32x32x16_bf16 v[96:111], v[216:219], v[40:43], v[96:111]
    ds_read_b64_tr_b16 v[56:57], v18 offset:3072
    ds_read_b64_tr_b16 v[58:59], v18 offset:3328
    buffer_load_dwordx4 v7, s[24:27], s64 offen offset:3072 lds
    s_waitcnt lgkmcnt(4)
    v_mfma_f32_32x32x16_bf16 v[64:79], v[48:51], v[220:223], v[64:79]
    s_waitcnt lgkmcnt(2)
    v_mfma_f32_32x32x16_bf16 v[80:95], v[52:55], v[220:223], v[80:95]
    s_waitcnt lgkmcnt(0)
    v_mfma_f32_32x32x16_bf16 v[96:111], v[220:223], v[56:59], v[96:111]
    v_subrev_u32 v12, 98304, v12
    v_subrev_u32 v13, 98304, v13
    v_subrev_u32 v14, 98304, v14
    v_subrev_u32 v15, 98304, v15
    v_subrev_u32 v16, 98304, v16
    v_subrev_u32 v17, 98304, v17
    v_subrev_u32 v18, 98304, v18
    s_waitcnt vmcnt(7)
    s_cmp_lg_u32 s48, 0
    s_cbranch_scc1 GB_P1_OK
    s_waitcnt vmcnt(6)
    s_mov_b32 s37, 262144
    s_add_u32 s38, s39, 1
GB_P1_CHK:
    v_subrev_u32 v29, s38, v29
    v_cmp_lt_u32 vcc, 3, v29
    s_cmp_eq_u64 vcc, 0
    s_cbranch_scc1 GB_P1_OK
    s_sub_u32 s37, s37, 1
    s_cmp_eq_u32 s37, 0
    s_cbranch_scc1 GB_P1_OK
    s_sleep 1
    buffer_load_dword v29, v28, s[40:43], 0 offen sc1
    s_waitcnt vmcnt(0)
    s_branch GB_P1_CHK
GB_P1_OK:
    s_barrier
    s_lshl_b32 s55, s50, 3
    s_add_u32 s55, s55, s48
    s_lshl_b32 s55, s55, 10
    s_add_u32 s55, s55, 23592960
    s_lshr_b32 s57, s48, 2
    s_mul_i32 s57, s57, 49152
    s_lshl_b32 s70, s56, 10
    s_add_u32 s57, s57, s70
    s_add_u32 m0, s57, 45056
    s_add_u32 s73, s57, 45824
    buffer_load_dwordx4 v2, s[40:43], s55 offen sc1 lds
    v_bfe_u32 v26, v1, 3, 2
    v_lshlrev_b32 v26, 13, v26
    v_and_b32 v27, 7, v1
    v_lshl_add_u32 v26, v27, 3, v26
    s_lshl_b32 s55, s48, 5
    s_add_u32 s55, s55, s49
    s_lshl_b32 s55, s55, 10
    s_add_u32 s55, s55, 23593600
    buffer_load_dwordx2 v[22:23], v26, s[40:43], s55 offen sc1
    ds_read_b128 v[224:227], v12 offset:0
    ds_read_b64_tr_b16 v[32:33], v16 offset:0
    ds_read_b64_tr_b16 v[34:35], v16 offset:512
    ds_read_b64_tr_b16 v[36:37], v17 offset:0
    ds_read_b64_tr_b16 v[38:39], v17 offset:512
    ds_read_b64_tr_b16 v[40:41], v18 offset:0
    ds_read_b64_tr_b16 v[42:43], v18 offset:256
    s_waitcnt lgkmcnt(4)
    v_mfma_f32_32x32x16_bf16 v[64:79], v[32:35], v[224:227], v[64:79]
    ds_read_b128 v[228:231], v13 offset:0
    ds_read_b64_tr_b16 v[48:49], v16 offset:2048
    ds_read_b64_tr_b16 v[50:51], v16 offset:2560
    s_add_u32 m0, s60, 98304
    s_add_u32 s64, s59, 0
    buffer_load_dwordx4 v24, s[32:35], s64 offen lds
    s_waitcnt lgkmcnt(5)
    v_mfma_f32_32x32x16_bf16 v[80:95], v[36:39], v[224:227], v[80:95]
    ds_read_b64_tr_b16 v[52:53], v17 offset:2048
    ds_read_b64_tr_b16 v[54:55], v17 offset:2560
    s_waitcnt lgkmcnt(5)
    v_mfma_f32_32x32x16_bf16 v[96:111], v[224:227], v[40:43], v[96:111]
    ds_read_b64_tr_b16 v[56:57], v18 offset:1024
    ds_read_b64_tr_b16 v[58:59], v18 offset:1280
    s_add_u32 m0, s60, 99328
    s_add_u32 s64, s59, 57344
    buffer_load_dwordx4 v24, s[32:35], s64 offen lds
    s_waitcnt lgkmcnt(4)
    v_mfma_f32_32x32x16_bf16 v[64:79], v[48:51], v[228:231], v[64:79]
    ds_read_b128 v[232:235], v14 offset:0
    ds_read_b64_tr_b16 v[32:33], v16 offset:4096
    ds_read_b64_tr_b16 v[34:35], v16 offset:4608
    s_add_u32 m0, s60, 100352
    s_add_u32 s64, s59, 114688
    buffer_load_dwordx4 v24, s[32:35], s64 offen lds
    s_waitcnt lgkmcnt(5)
    v_mfma_f32_32x32x16_bf16 v[80:95], v[52:55], v[228:231], v[80:95]
    ds_read_b64_tr_b16 v[36:37], v17 offset:4096
    ds_read_b64_tr_b16 v[38:39], v17 offset:4608
    s_waitcnt lgkmcnt(5)
    v_mfma_f32_32x32x16_bf16 v[96:111], v[228:231], v[56:59], v[96:111]
    ds_read_b64_tr_b16 v[40:41], v18 offset:2048
    ds_read_b64_tr_b16 v[42:43], v18 offset:2304
    s_add_u32 m0, s60, 101376
    s_add_u32 s64, s59, 172032
    buffer_load_dwordx4 v24, s[32:35], s64 offen lds
    s_waitcnt lgkmcnt(4)
    v_mfma_f32_32x32x16_bf16 v[64:79], v[32:35], v[232:235], v[64:79]
    ds_read_b128 v[236:239], v15 offset:0
    ds_read_b64_tr_b16 v[48:49], v16 offset:6144
    ds_read_b64_tr_b16 v[50:51], v16 offset:6656
    s_add_u32 m0, s60, 131072
    s_add_u32 s64, s63, 0
    buffer_load_dwordx4 v24, s[32:35], s64 offen lds
    s_waitcnt lgkmcnt(5)
    v_mfma_f32_32x32x16_bf16 v[80:95], v[36:39], v[232:235], v[80:95]
    ds_read_b64_tr_b16 v[52:53], v17 offset:6144
    ds_read_b64_tr_b16 v[54:55], v17 offset:6656
    s_waitcnt lgkmcnt(5)
    v_mfma_f32_32x32x16_bf16 v[96:111], v[232:235], v[40:43], v[96:111]
    ds_read_b64_tr_b16 v[56:57], v18 offset:3072
    ds_read_b64_tr_b16 v[58:59], v18 offset:3328
    s_add_u32 m0, s60, 132096
    s_add_u32 s64, s63, 57344
    buffer_load_dwordx4 v24, s[32:35], s64 offen lds
    s_waitcnt lgkmcnt(4)
    v_mfma_f32_32x32x16_bf16 v[64:79], v[48:51], v[236:239], v[64:79]
    s_add_u32 m0, s60, 133120
    s_add_u32 s64, s63, 114688
    buffer_load_dwordx4 v24, s[32:35], s64 offen lds
    s_waitcnt lgkmcnt(2)
    v_mfma_f32_32x32x16_bf16 v[80:95], v[52:55], v[236:239], v[80:95]
    s_waitcnt lgkmcnt(0)
    v_mfma_f32_32x32x16_bf16 v[96:111], v[236:239], v[56:59], v[96:111]
    s_add_u32 m0, s60, 134144
    s_add_u32 s64, s63, 172032
    buffer_load_dwordx4 v24, s[32:35], s64 offen lds
    s_waitcnt vmcnt(10)
    s_barrier
    ds_read_b128 v[240:243], v12 offset:49152
    ds_read_b64_tr_b16 v[32:33], v16 offset:49152
    ds_read_b64_tr_b16 v[34:35], v16 offset:49664
    ds_read_b64_tr_b16 v[36:37], v17 offset:49152
    ds_read_b64_tr_b16 v[38:39], v17 offset:49664
    ds_read_b64_tr_b16 v[40:41], v18 offset:49152
    ds_read_b64_tr_b16 v[42:43], v18 offset:49408
    s_waitcnt lgkmcnt(4)
    v_mfma_f32_32x32x16_bf16 v[64:79], v[32:35], v[240:243], v[64:79]
    ds_read_b128 v[244:247], v13 offset:49152
    ds_read_b64_tr_b16 v[48:49], v16 offset:51200
    ds_read_b64_tr_b16 v[50:51], v16 offset:51712
    s_waitcnt lgkmcnt(5)
    v_mfma_f32_32x32x16_bf16 v[80:95], v[36:39], v[240:243], v[80:95]
    ds_read_b64_tr_b16 v[52:53], v17 offset:51200
    ds_read_b64_tr_b16 v[54:55], v17 offset:51712
    s_waitcnt lgkmcnt(5)
    v_mfma_f32_32x32x16_bf16 v[96:111], v[240:243], v[40:43], v[96:111]
    ds_read_b64_tr_b16 v[56:57], v18 offset:50176
    ds_read_b64_tr_b16 v[58:59], v18 offset:50432
    s_waitcnt lgkmcnt(4)
    v_mfma_f32_32x32x16_bf16 v[64:79], v[48:51], v[244:247], v[64:79]
    ds_read_b128 v[248:251], v14 offset:49152
    ds_read_b64_tr_b16 v[32:33], v16 offset:53248
    ds_read_b64_tr_b16 v[34:35], v16 offset:53760
    s_waitcnt lgkmcnt(5)
    v_mfma_f32_32x32x16_bf16 v[80:95], v[52:55], v[244:247], v[80:95]
    ds_read_b64_tr_b16 v[36:37], v17 offset:53248
    ds_read_b64_tr_b16 v[38:39], v17 offset:53760
    s_waitcnt lgkmcnt(5)
    v_mfma_f32_32x32x16_bf16 v[96:111], v[244:247], v[56:59], v[96:111]
    ds_read_b64_tr_b16 v[40:41], v18 offset:51200
    ds_read_b64_tr_b16 v[42:43], v18 offset:51456
    s_waitcnt lgkmcnt(4)
    v_mfma_f32_32x32x16_bf16 v[64:79], v[32:35], v[248:251], v[64:79]
    ds_read_b128 v[252:255], v15 offset:49152
    ds_read_b64_tr_b16 v[48:49], v16 offset:55296
    ds_read_b64_tr_b16 v[50:51], v16 offset:55808
    s_waitcnt lgkmcnt(5)
    v_mfma_f32_32x32x16_bf16 v[80:95], v[36:39], v[248:251], v[80:95]
    ds_read_b64_tr_b16 v[52:53], v17 offset:55296
    ds_read_b64_tr_b16 v[54:55], v17 offset:55808
    s_waitcnt lgkmcnt(5)
    v_mfma_f32_32x32x16_bf16 v[96:111], v[248:251], v[40:43], v[96:111]
    ds_read_b64_tr_b16 v[56:57], v18 offset:52224
    ds_read_b64_tr_b16 v[58:59], v18 offset:52480
    s_waitcnt lgkmcnt(4)
    v_mfma_f32_32x32x16_bf16 v[64:79], v[48:51], v[252:255], v[64:79]
    s_waitcnt lgkmcnt(2)
    v_mfma_f32_32x32x16_bf16 v[80:95], v[52:55], v[252:255], v[80:95]
    s_waitcnt lgkmcnt(0)
    v_mfma_f32_32x32x16_bf16 v[96:111], v[252:255], v[56:59], v[96:111]
    v_bfe_u32 v24, v1, 4, 1
    v_lshrrev_b32 v25, 5, v1
    v_bfe_u32 v26, v1, 2, 2
    v_and_b32 v27, 3, v1
    v_lshl_add_u32 v26, v25, 3, v26
    v_lshlrev_b32 v12, 6, v26
    v_lshl_add_u32 v12, v27, 3, v12
    v_mul_u32_u24 v13, 16416, v24
    v_add_u32 v12, v12, v13
    v_add_u32 v12, 98304, v12
    v_xor_b32 v13, 32, v12
    v_mov_b32 v5, 0
    v_mov_b32 v6, 0
    v_mov_b32 v7, 0
    v_mov_b32 v21, 0
    v_and_b32 v30, 31, v1
    v_lshlrev_b32 v24, 2, v30
    v_mul_u32_u24 v30, 49152, v25
    v_add_u32 v30, v30, v24
    v_add_u32 v30, 45056, v30
    s_mul_i32 s75, s54, 112
    s_waitcnt vmcnt(0)
    v_mov_b32 v20, v22
    v_mov_b32 v28, v23
    v_mov_b32 v22, 0
    v_mov_b32 v23, 0
    v_mul_f32 v29, 0xbfb8aa3b, v28
    v_add_u32 v25, s73, v24
    ds_write_b32 v25, v28
    s_cmp_lg_u32 s50, 0
    s_cbranch_scc1 GB_NORS
    s_lshl_b32 s74, s54, 7
    s_add_u32 s74, s74, 19922944
    buffer_store_dword v28, v24, s[40:43], s74 offen sc1
GB_NORS:
    s_waitcnt lgkmcnt(0)
    s_barrier
    v_add_u32 v31, 0, v30
    ds_read2st64_b32 v[24:25], v31 offset0:0 offset1:4
    ds_read2st64_b32 v[26:27], v31 offset0:8 offset1:12
    v_add_u32 v31, 128, v30
    ds_read2st64_b32 v[14:15], v31 offset0:0 offset1:4
    ds_read2st64_b32 v[16:17], v31 offset0:8 offset1:12
    ds_read_b64_tr_b16 v[48:49], v12 offset:0
    ds_read_b64_tr_b16 v[50:51], v12 offset:256
    ds_read_b64_tr_b16 v[52:53], v13 offset:0
    ds_read_b64_tr_b16 v[54:55], v13 offset:256
    ds_read_b64_tr_b16 v[56:57], v12 offset:1024
    ds_read_b64_tr_b16 v[58:59], v12 offset:1280
    s_lshl_b32 s74, s53, 1
    s_add_u32 s66, s75, s74
    s_add_u32 s66, s66, 64
    s_lshl_b32 s66, s66, 10
    s_add_u32 s66, s66, 8388608
    v_mul_f32 v19, 0x3eb8aa3b, v28
    s_lshl_b32 s71, s53, 17
    s_lshl_b32 s72, s54, 10
    s_add_u32 s71, s71, s72
    s_add_u32 s71, s71, 0
    s_add_u32 s72, s71, 65536
    s_add_u32 s74, s71, 2097152
    s_add_u32 s67, s72, 2097152
    s_add_u32 s70, s71, 4194304
    v_bfe_u32 v8, v1, 4, 1
    v_lshlrev_b32 v8, 16, v8
    v_lshrrev_b32 v9, 5, v1
    v_lshl_add_u32 v8, v9, 8, v8
    v_lshlrev_b32 v10, 4, v9
    v_add_u32 v10, s73, v10
    v_and_b32 v9, 15, v1
    v_lshl_add_u32 v8, v9, 4, v8
    s_waitcnt lgkmcnt(4)
    v_mfma_f32_32x32x16_bf16 v[112:127], v[48:51], v[128:131], 0
    ds_read_b64_tr_b16 v[60:61], v13 offset:1024
    ds_read_b64_tr_b16 v[62:63], v13 offset:1280
    s_waitcnt lgkmcnt(4)
    v_mfma_f32_32x32x16_bf16 v[32:47], v[52:55], v[128:131], 0
    ds_read_b64_tr_b16 v[48:49], v12 offset:2048
    ds_read_b64_tr_b16 v[50:51], v12 offset:2304
    v_add_f32 v24, v24, v25
    v_add_f32 v26, v26, v27
    v_add_f32 v24, v24, v26
    v_cvt_pk_bf16_f32 v25, v24, v24
    v_lshlrev_b32 v25, 16, v25
    v_sub_f32 v25, v24, v25
    v_cvt_pk_bf16_f32 v4, v24, v25
    s_nop 1
    v_mfma_f32_32x32x16_bf16 v[64:79], v[4:7], v[20:23], v[64:79]
    v_add_f32 v14, v14, v15
    v_add_f32 v16, v16, v17
    v_add_f32 v14, v14, v16
    v_cvt_pk_bf16_f32 v15, v14, v14
    v_lshlrev_b32 v15, 16, v15
    v_sub_f32 v15, v14, v15
    v_cvt_pk_bf16_f32 v4, v14, v15
    s_nop 1
    v_mfma_f32_32x32x16_bf16 v[80:95], v[4:7], v[20:23], v[80:95]
    v_add_u32 v31, 256, v30
    ds_read2st64_b32 v[24:25], v31 offset0:0 offset1:4
    ds_read2st64_b32 v[26:27], v31 offset0:8 offset1:12
    s_waitcnt lgkmcnt(0)
    v_add_f32 v24, v24, v25
    v_add_f32 v26, v26, v27
    v_add_f32 v24, v24, v26
    v_cvt_pk_bf16_f32 v25, v24, v24
    v_lshlrev_b32 v25, 16, v25
    v_sub_f32 v25, v24, v25
    v_cvt_pk_bf16_f32 v4, v24, v25
    s_nop 1
    v_mfma_f32_32x32x16_bf16 v[96:111], v[20:23], v[4:7], v[96:111]
    v_mul_f32 v80, v28, v80
    v_mul_f32 v81, v28, v81
    v_mul_f32 v82, v28, v82
    v_mul_f32 v83, v28, v83
    v_mul_f32 v84, v28, v84
    v_mul_f32 v85, v28, v85
    v_mul_f32 v86, v28, v86
    v_mul_f32 v87, v28, v87
    v_cvt_pk_bf16_f32 v80, v80, v81
    v_cvt_pk_bf16_f32 v81, v82, v83
    v_cvt_pk_bf16_f32 v82, v84, v85
    v_cvt_pk_bf16_f32 v83, v86, v87
    buffer_store_dwordx4 v[80:83], v2, s[40:43], s74 offen sc1
    v_mul_f32 v88, v28, v88
    v_mul_f32 v89, v28, v89
    v_mul_f32 v90, v28, v90
    v_mul_f32 v91, v28, v91
    v_mul_f32 v92, v28, v92
    v_mul_f32 v93, v28, v93
    v_mul_f32 v94, v28, v94
    v_mul_f32 v95, v28, v95
    v_cvt_pk_bf16_f32 v88, v88, v89
    v_cvt_pk_bf16_f32 v89, v90, v91
    v_cvt_pk_bf16_f32 v90, v92, v93
    v_cvt_pk_bf16_f32 v91, v94, v95
    buffer_store_dwordx4 v[88:91], v2, s[40:43], s67 offen sc1
    ds_read_b128 v[24:27], v10 offset:0
    ds_read_b128 v[14:17], v10 offset:32
    s_waitcnt lgkmcnt(0)
    v_mul_f32 v96, v24, v96
    v_mul_f32 v97, v25, v97
    v_mul_f32 v98, v26, v98
    v_mul_f32 v99, v27, v99
    v_mul_f32 v100, v14, v100
    v_mul_f32 v101, v15, v101
    v_mul_f32 v102, v16, v102
    v_mul_f32 v103, v17, v103
    v_cvt_pk_bf16_f32 v96, v96, v97
    v_cvt_pk_bf16_f32 v97, v98, v99
    s_waitcnt lgkmcnt(4)
    v_mfma_f32_32x32x16_bf16 v[112:127], v[56:59], v[132:135], v[112:127]
    ds_read_b64_tr_b16 v[52:53], v13 offset:2048
    ds_read_b64_tr_b16 v[54:55], v13 offset:2304
    v_cvt_pk_bf16_f32 v98, v100, v101
    v_cvt_pk_bf16_f32 v99, v102, v103
    buffer_store_dwordx4 v[96:99], v8, s[40:43], s70 offen offset:0 sc1
    ds_read_b128 v[24:27], v10 offset:64
    ds_read_b128 v[14:17], v10 offset:96
    s_waitcnt lgkmcnt(0)
    v_mul_f32 v104, v24, v104
    v_mul_f32 v105, v25, v105
    v_mul_f32 v106, v26, v106
    v_mul_f32 v107, v27, v107
    v_mul_f32 v108, v14, v108
    v_mul_f32 v109, v15, v109
    v_mul_f32 v110, v16, v110
    v_mul_f32 v111, v17, v111
    v_cvt_pk_bf16_f32 v104, v104, v105
    v_cvt_pk_bf16_f32 v105, v106, v107
    v_cvt_pk_bf16_f32 v106, v108, v109
    v_cvt_pk_bf16_f32 v107, v110, v111
    buffer_store_dwordx4 v[104:107], v8, s[40:43], s70 offen offset:512 sc1
    v_mul_f32 v64, v19, v64
    v_mul_f32 v65, v19, v65
    v_mul_f32 v66, v19, v66
    v_mul_f32 v67, v19, v67
    v_mul_f32 v68, v19, v68
    v_mul_f32 v69, v19, v69
    v_mul_f32 v70, v19, v70
    v_mul_f32 v71, v19, v71
    v_cvt_pk_bf16_f32 v64, v64, v65
    v_cvt_pk_bf16_f32 v65, v66, v67
    v_cvt_pk_bf16_f32 v66, v68, v69
    v_cvt_pk_bf16_f32 v67, v70, v71
    buffer_store_dwordx4 v[64:67], v2, s[40:43], s71 offen sc1
    v_mul_f32 v72, v19, v72
    v_mul_f32 v73, v19, v73
    v_mul_f32 v74, v19, v74
    v_mul_f32 v75, v19, v75
    v_mul_f32 v76, v19, v76
    v_mul_f32 v77, v19, v77
    v_mul_f32 v78, v19, v78
    v_mul_f32 v79, v19, v79
    v_cvt_pk_bf16_f32 v72, v72, v73
    v_cvt_pk_bf16_f32 v73, v74, v75
    v_cvt_pk_bf16_f32 v74, v76, v77
    v_cvt_pk_bf16_f32 v75, v78, v79
    buffer_store_dwordx4 v[72:75], v2, s[40:43], s72 offen sc1
    v_add_u32 v31, 384, v30
    ds_read2st64_b32 v[24:25], v31 offset0:0 offset1:4
    ds_read2st64_b32 v[26:27], v31 offset0:8 offset1:12
    v_add_u32 v31, 512, v30
    ds_read2st64_b32 v[14:15], v31 offset0:0 offset1:4
    ds_read2st64_b32 v[16:17], v31 offset0:8 offset1:12
    s_waitcnt lgkmcnt(0)
    v_add_f32 v24, v24, v25
    v_add_f32 v26, v26, v27
    v_add_f32 v24, v24, v26
    v_cvt_pk_bf16_f32 v25, v24, v24
    v_lshlrev_b32 v25, 16, v25
    v_sub_f32 v25, v24, v25
    v_cvt_pk_bf16_f32 v4, v24, v25
    s_nop 1
    v_mfma_f32_32x32x16_bf16 v[112:127], v[4:7], v[20:23], v[112:127]
    v_add_f32 v14, v14, v15
    v_add_f32 v16, v16, v17
    v_add_f32 v14, v14, v16
    v_cvt_pk_bf16_f32 v15, v14, v14
    v_lshlrev_b32 v15, 16, v15
    v_sub_f32 v15, v14, v15
    v_cvt_pk_bf16_f32 v4, v14, v15
    s_nop 1
    v_mfma_f32_32x32x16_bf16 v[32:47], v[4:7], v[20:23], v[32:47]
    s_waitcnt lgkmcnt(4)
    v_mfma_f32_32x32x16_bf16 v[32:47], v[60:63], v[132:135], v[32:47]
    ds_read_b64_tr_b16 v[56:57], v12 offset:3072
    ds_read_b64_tr_b16 v[58:59], v12 offset:3328
    s_waitcnt lgkmcnt(4)
    v_mfma_f32_32x32x16_bf16 v[112:127], v[48:51], v[136:139], v[112:127]
    ds_read_b64_tr_b16 v[60:61], v13 offset:3072
    ds_read_b64_tr_b16 v[62:63], v13 offset:3328
    s_waitcnt lgkmcnt(4)
    v_mfma_f32_32x32x16_bf16 v[32:47], v[52:55], v[136:139], v[32:47]
    ds_read_b64_tr_b16 v[48:49], v12 offset:4096
    ds_read_b64_tr_b16 v[50:51], v12 offset:4352
    s_waitcnt lgkmcnt(4)
    v_mfma_f32_32x32x16_bf16 v[112:127], v[56:59], v[140:143], v[112:127]
    ds_read_b64_tr_b16 v[52:53], v13 offset:4096
    ds_read_b64_tr_b16 v[54:55], v13 offset:4352
    s_waitcnt lgkmcnt(4)
    v_mfma_f32_32x32x16_bf16 v[32:47], v[60:63], v[140:143], v[32:47]
    ds_read_b64_tr_b16 v[56:57], v12 offset:5120
    ds_read_b64_tr_b16 v[58:59], v12 offset:5376
    s_waitcnt lgkmcnt(4)
    v_mfma_f32_32x32x16_bf16 v[112:127], v[48:51], v[144:147], v[112:127]
    ds_read_b64_tr_b16 v[60:61], v13 offset:5120
    ds_read_b64_tr_b16 v[62:63], v13 offset:5376
    s_waitcnt lgkmcnt(4)
    v_mfma_f32_32x32x16_bf16 v[32:47], v[52:55], v[144:147], v[32:47]
    ds_read_b64_tr_b16 v[48:49], v12 offset:6144
    ds_read_b64_tr_b16 v[50:51], v12 offset:6400
    s_waitcnt lgkmcnt(4)
    v_mfma_f32_32x32x16_bf16 v[112:127], v[56:59], v[148:151], v[112:127]
    ds_read_b64_tr_b16 v[52:53], v13 offset:6144
    ds_read_b64_tr_b16 v[54:55], v13 offset:6400
    s_waitcnt lgkmcnt(4)
    v_mfma_f32_32x32x16_bf16 v[32:47], v[60:63], v[148:151], v[32:47]
    ds_read_b64_tr_b16 v[56:57], v12 offset:7168
    ds_read_b64_tr_b16 v[58:59], v12 offset:7424
    s_waitcnt lgkmcnt(4)
    v_mfma_f32_32x32x16_bf16 v[112:127], v[48:51], v[152:155], v[112:127]
    ds_read_b64_tr_b16 v[60:61], v13 offset:7168
    ds_read_b64_tr_b16 v[62:63], v13 offset:7424
    s_waitcnt vmcnt(0)
    s_barrier
    s_cmp_lg_u32 s48, 0
    s_cbranch_scc1 GB_FL2
    s_add_u32 s37, s39, 2
    v_mov_b32 v0, s37
    s_mov_b32 exec_hi, 0
    buffer_store_dword v0, v11, s[40:43], s36 offen sc1
    s_mov_b32 exec_hi, -1
GB_FL2:
    s_waitcnt lgkmcnt(4)
    v_mfma_f32_32x32x16_bf16 v[32:47], v[52:55], v[152:155], v[32:47]
    ds_read_b64_tr_b16 v[48:49], v12 offset:8192
    ds_read_b64_tr_b16 v[50:51], v12 offset:8448
    s_waitcnt lgkmcnt(4)
    v_mfma_f32_32x32x16_bf16 v[112:127], v[56:59], v[156:159], v[112:127]
    ds_read_b64_tr_b16 v[52:53], v13 offset:8192
    ds_read_b64_tr_b16 v[54:55], v13 offset:8448
    s_waitcnt lgkmcnt(4)
    v_mfma_f32_32x32x16_bf16 v[32:47], v[60:63], v[156:159], v[32:47]
    ds_read_b64_tr_b16 v[56:57], v12 offset:9216
    ds_read_b64_tr_b16 v[58:59], v12 offset:9472
    s_waitcnt lgkmcnt(4)
    v_mfma_f32_32x32x16_bf16 v[112:127], v[48:51], v[160:163], v[112:127]
    ds_read_b64_tr_b16 v[60:61], v13 offset:9216
    ds_read_b64_tr_b16 v[62:63], v13 offset:9472
    s_waitcnt lgkmcnt(4)
    v_mfma_f32_32x32x16_bf16 v[32:47], v[52:55], v[160:163], v[32:47]
    ds_read_b64_tr_b16 v[48:49], v12 offset:10240
    ds_read_b64_tr_b16 v[50:51], v12 offset:10496
    s_waitcnt lgkmcnt(4)
    v_mfma_f32_32x32x16_bf16 v[112:127], v[56:59], v[164:167], v[112:127]
    ds_read_b64_tr_b16 v[52:53], v13 offset:10240
    ds_read_b64_tr_b16 v[54:55], v13 offset:10496
    s_waitcnt lgkmcnt(4)
    v_mfma_f32_32x32x16_bf16 v[32:47], v[60:63], v[164:167], v[32:47]
    ds_read_b64_tr_b16 v[56:57], v12 offset:11264
    ds_read_b64_tr_b16 v[58:59], v12 offset:11520
    s_waitcnt lgkmcnt(4)
    v_mfma_f32_32x32x16_bf16 v[112:127], v[48:51], v[168:171], v[112:127]
    ds_read_b64_tr_b16 v[60:61], v13 offset:11264
    ds_read_b64_tr_b16 v[62:63], v13 offset:11520
    s_waitcnt lgkmcnt(4)
    v_mfma_f32_32x32x16_bf16 v[32:47], v[52:55], v[168:171], v[32:47]
    ds_read_b64_tr_b16 v[48:49], v12 offset:12288
    ds_read_b64_tr_b16 v[50:51], v12 offset:12544
    s_waitcnt lgkmcnt(4)
    v_mfma_f32_32x32x16_bf16 v[112:127], v[56:59], v[172:175], v[112:127]
    ds_read_b64_tr_b16 v[52:53], v13 offset:12288
    ds_read_b64_tr_b16 v[54:55], v13 offset:12544
    s_waitcnt lgkmcnt(4)
    v_mfma_f32_32x32x16_bf16 v[32:47], v[60:63], v[172:175], v[32:47]
    ds_read_b64_tr_b16 v[56:57], v12 offset:13312
    ds_read_b64_tr_b16 v[58:59], v12 offset:13568
    s_waitcnt lgkmcnt(4)
    v_mfma_f32_32x32x16_bf16 v[112:127], v[48:51], v[176:179], v[112:127]
    ds_read_b64_tr_b16 v[60:61], v13 offset:13312
    ds_read_b64_tr_b16 v[62:63], v13 offset:13568
    s_waitcnt lgkmcnt(4)
    v_mfma_f32_32x32x16_bf16 v[32:47], v[52:55], v[176:179], v[32:47]
    ds_read_b64_tr_b16 v[48:49], v12 offset:14336
    ds_read_b64_tr_b16 v[50:51], v12 offset:14592
    s_waitcnt lgkmcnt(4)
    v_mfma_f32_32x32x16_bf16 v[112:127], v[56:59], v[180:183], v[112:127]
    ds_read_b64_tr_b16 v[52:53], v13 offset:14336
    ds_read_b64_tr_b16 v[54:55], v13 offset:14592
    s_waitcnt lgkmcnt(4)
    v_mfma_f32_32x32x16_bf16 v[32:47], v[60:63], v[180:183], v[32:47]
    ds_read_b64_tr_b16 v[56:57], v12 offset:15360
    ds_read_b64_tr_b16 v[58:59], v12 offset:15616
    s_waitcnt lgkmcnt(4)
    v_mfma_f32_32x32x16_bf16 v[112:127], v[48:51], v[184:187], v[112:127]
    ds_read_b64_tr_b16 v[60:61], v13 offset:15360
    ds_read_b64_tr_b16 v[62:63], v13 offset:15616
    s_waitcnt lgkmcnt(4)
    v_mfma_f32_32x32x16_bf16 v[32:47], v[52:55], v[184:187], v[32:47]
    ds_read_b64_tr_b16 v[48:49], v12 offset:32768
    ds_read_b64_tr_b16 v[50:51], v12 offset:33024
    s_waitcnt lgkmcnt(4)
    v_mfma_f32_32x32x16_bf16 v[112:127], v[56:59], v[188:191], v[112:127]
    ds_read_b64_tr_b16 v[52:53], v13 offset:32768
    ds_read_b64_tr_b16 v[54:55], v13 offset:33024
    s_waitcnt lgkmcnt(4)
    v_mfma_f32_32x32x16_bf16 v[32:47], v[60:63], v[188:191], v[32:47]
    ds_read_b64_tr_b16 v[56:57], v12 offset:33792
    ds_read_b64_tr_b16 v[58:59], v12 offset:34048
    s_waitcnt lgkmcnt(4)
    v_mfma_f32_32x32x16_bf16 v[112:127], v[48:51], v[192:195], v[112:127]
    ds_read_b64_tr_b16 v[60:61], v13 offset:33792
    ds_read_b64_tr_b16 v[62:63], v13 offset:34048
    s_waitcnt lgkmcnt(4)
    v_mfma_f32_32x32x16_bf16 v[32:47], v[52:55], v[192:195], v[32:47]
    ds_read_b64_tr_b16 v[48:49], v12 offset:34816
    ds_read_b64_tr_b16 v[50:51], v12 offset:35072
    s_waitcnt lgkmcnt(4)
    v_mfma_f32_32x32x16_bf16 v[112:127], v[56:59], v[196:199], v[112:127]
    ds_read_b64_tr_b16 v[52:53], v13 offset:34816
    ds_read_b64_tr_b16 v[54:55], v13 offset:35072
    s_waitcnt lgkmcnt(4)
    v_mfma_f32_32x32x16_bf16 v[32:47], v[60:63], v[196:199], v[32:47]
    ds_read_b64_tr_b16 v[56:57], v12 offset:35840
    ds_read_b64_tr_b16 v[58:59], v12 offset:36096
    s_waitcnt lgkmcnt(4)
    v_mfma_f32_32x32x16_bf16 v[112:127], v[48:51], v[200:203], v[112:127]
    ds_read_b64_tr_b16 v[60:61], v13 offset:35840
    ds_read_b64_tr_b16 v[62:63], v13 offset:36096
    s_waitcnt lgkmcnt(4)
    v_mfma_f32_32x32x16_bf16 v[32:47], v[52:55], v[200:203], v[32:47]
    ds_read_b64_tr_b16 v[48:49], v12 offset:36864
    ds_read_b64_tr_b16 v[50:51], v12 offset:37120
    s_waitcnt lgkmcnt(4)
    v_mfma_f32_32x32x16_bf16 v[112:127], v[56:59], v[204:207], v[112:127]
    ds_read_b64_tr_b16 v[52:53], v13 offset:36864
    ds_read_b64_tr_b16 v[54:55], v13 offset:37120
    s_waitcnt lgkmcnt(4)
    v_mfma_f32_32x32x16_bf16 v[32:47], v[60:63], v[204:207], v[32:47]
    ds_read_b64_tr_b16 v[56:57], v12 offset:37888
    ds_read_b64_tr_b16 v[58:59], v12 offset:38144
    s_waitcnt lgkmcnt(4)
    v_mfma_f32_32x32x16_bf16 v[112:127], v[48:51], v[208:211], v[112:127]
    ds_read_b64_tr_b16 v[60:61], v13 offset:37888
    ds_read_b64_tr_b16 v[62:63], v13 offset:38144
    s_waitcnt lgkmcnt(4)
    v_mfma_f32_32x32x16_bf16 v[32:47], v[52:55], v[208:211], v[32:47]
    ds_read_b64_tr_b16 v[48:49], v12 offset:38912
    ds_read_b64_tr_b16 v[50:51], v12 offset:39168
    s_waitcnt lgkmcnt(4)
    v_mfma_f32_32x32x16_bf16 v[112:127], v[56:59], v[212:215], v[112:127]
    ds_read_b64_tr_b16 v[52:53], v13 offset:38912
    ds_read_b64_tr_b16 v[54:55], v13 offset:39168
    s_waitcnt lgkmcnt(4)
    v_mfma_f32_32x32x16_bf16 v[32:47], v[60:63], v[212:215], v[32:47]
    ds_read_b64_tr_b16 v[56:57], v12 offset:39936
    ds_read_b64_tr_b16 v[58:59], v12 offset:40192
    s_waitcnt lgkmcnt(4)
    v_mfma_f32_32x32x16_bf16 v[112:127], v[48:51], v[216:219], v[112:127]
    ds_read_b64_tr_b16 v[60:61], v13 offset:39936
    ds_read_b64_tr_b16 v[62:63], v13 offset:40192
    s_cmp_lg_u32 s48, 0
    s_cbranch_scc1 GB_NOP2
    s_bfe_u32 s55, s2, 0x20001
    s_bfe_u32 s57, s2, 0x20003
    s_lshl_b32 s57, s57, 3
    s_add_u32 s55, s55, s57
    s_lshl_b32 s55, s55, 3
    v_min_u32 v9, 7, v1
    v_add_u32 v9, s55, v9
    v_lshlrev_b32 v9, 7, v9
    v_add_u32 v9, 23068672, v9
    buffer_load_dword v3, v9, s[40:43], 0 offen sc1
GB_NOP2:
    s_waitcnt lgkmcnt(4)
    v_mfma_f32_32x32x16_bf16 v[32:47], v[52:55], v[216:219], v[32:47]
    ds_read_b64_tr_b16 v[48:49], v12 offset:40960
    ds_read_b64_tr_b16 v[50:51], v12 offset:41216
    s_waitcnt lgkmcnt(4)
    v_mfma_f32_32x32x16_bf16 v[112:127], v[56:59], v[220:223], v[112:127]
    ds_read_b64_tr_b16 v[52:53], v13 offset:40960
    ds_read_b64_tr_b16 v[54:55], v13 offset:41216
    s_waitcnt lgkmcnt(4)
    v_mfma_f32_32x32x16_bf16 v[32:47], v[60:63], v[220:223], v[32:47]
    ds_read_b64_tr_b16 v[56:57], v12 offset:41984
    ds_read_b64_tr_b16 v[58:59], v12 offset:42240
    s_waitcnt lgkmcnt(4)
    v_mfma_f32_32x32x16_bf16 v[112:127], v[48:51], v[224:227], v[112:127]
    ds_read_b64_tr_b16 v[60:61], v13 offset:41984
    ds_read_b64_tr_b16 v[62:63], v13 offset:42240
    s_waitcnt lgkmcnt(4)
    v_mfma_f32_32x32x16_bf16 v[32:47], v[52:55], v[224:227], v[32:47]
    ds_read_b64_tr_b16 v[48:49], v12 offset:43008
    ds_read_b64_tr_b16 v[50:51], v12 offset:43264
    s_waitcnt lgkmcnt(4)
    v_mfma_f32_32x32x16_bf16 v[112:127], v[56:59], v[228:231], v[112:127]
    ds_read_b64_tr_b16 v[52:53], v13 offset:43008
    ds_read_b64_tr_b16 v[54:55], v13 offset:43264
    s_waitcnt lgkmcnt(4)
    v_mfma_f32_32x32x16_bf16 v[32:47], v[60:63], v[228:231], v[32:47]
    ds_read_b64_tr_b16 v[56:57], v12 offset:44032
    ds_read_b64_tr_b16 v[58:59], v12 offset:44288
    s_waitcnt lgkmcnt(4)
    v_mfma_f32_32x32x16_bf16 v[112:127], v[48:51], v[232:235], v[112:127]
    ds_read_b64_tr_b16 v[60:61], v13 offset:44032
    ds_read_b64_tr_b16 v[62:63], v13 offset:44288
    s_cmp_lg_u32 s48, 0
    s_cbranch_scc1 GB_P2_OK
    s_waitcnt vmcnt(0)
    s_mov_b32 s37, 262144
    s_add_u32 s38, s39, 2
GB_P2_CHK:
    v_subrev_u32 v3, s38, v3
    v_cmp_lt_u32 vcc, 3, v3
    s_cmp_eq_u64 vcc, 0
    s_cbranch_scc1 GB_P2_OK
    s_sub_u32 s37, s37, 1
    s_cmp_eq_u32 s37, 0
    s_cbranch_scc1 GB_P2_OK
    s_sleep 1
    buffer_load_dword v3, v9, s[40:43], 0 offen sc1
    s_waitcnt vmcnt(0)
    s_branch GB_P2_CHK
GB_P2_OK:
    s_barrier
    s_and_b32 s49, s2, 7
    s_bfe_u32 s50, s2, 0x20003
    s_lshl_b32 s51, s50, 3
    s_add_u32 s51, s51, s49
    s_lshl_b32 s49, s49, 2
    s_add_u32 s49, s49, s50
    s_lshr_b32 s50, s2, 5
    s_and_b32 s52, s48, 3
    s_lshr_b32 s53, s48, 2
    s_lshl_b32 s54, s51, 16
    s_lshl_b32 s55, s50, 3
    s_lshl_b32 s56, s52, 1
    s_add_u32 s55, s55, s56
    s_lshl_b32 s56, s55, 10
    s_add_u32 s56, s56, s54
    s_add_u32 s56, s56, 0
    s_lshl_b32 s57, s53, 15
    s_lshl_b32 s58, s52, 10
    s_add_u32 s58, s58, s57
    s_add_u32 s58, s58, s54
    s_add_u32 s59, s58, 4194304
    s_add_u32 s58, s58, 2097152
    s_lshl_b32 s57, s48, 10
    s_waitcnt lgkmcnt(4)
    v_mfma_f32_32x32x16_bf16 v[32:47], v[52:55], v[232:235], v[32:47]
    ds_read_b64_tr_b16 v[48:49], v12 offset:45056
    ds_read_b64_tr_b16 v[50:51], v12 offset:45312
    s_add_u32 m0, s57, 0
    s_add_u32 s62, s58, 0
    buffer_load_dwordx4 v2, s[40:43], s62 offen sc1 lds
    s_waitcnt lgkmcnt(4)
    v_mfma_f32_32x32x16_bf16 v[112:127], v[56:59], v[236:239], v[112:127]
    ds_read_b64_tr_b16 v[52:53], v13 offset:45056
    ds_read_b64_tr_b16 v[54:55], v13 offset:45312
    buffer_load_dwordx4 v[64:67], v2, s[40:43], s56 offen sc1
    s_waitcnt lgkmcnt(4)
    v_mfma_f32_32x32x16_bf16 v[32:47], v[60:63], v[236:239], v[32:47]
    ds_read_b64_tr_b16 v[56:57], v12 offset:46080
    ds_read_b64_tr_b16 v[58:59], v12 offset:46336
    buffer_load_dwordx4 v[68:71], v2, s[40:43], s56 offen offset:1024 sc1
    s_waitcnt lgkmcnt(4)
    v_mfma_f32_32x32x16_bf16 v[112:127], v[48:51], v[240:243], v[112:127]
    ds_read_b64_tr_b16 v[60:61], v13 offset:46080
    ds_read_b64_tr_b16 v[62:63], v13 offset:46336
    s_add_u32 m0, s57, 8192
    s_add_u32 s62, s59, 0
    buffer_load_dwordx4 v2, s[40:43], s62 offen sc1 lds
    s_waitcnt lgkmcnt(4)
    v_mfma_f32_32x32x16_bf16 v[32:47], v[52:55], v[240:243], v[32:47]
    ds_read_b64_tr_b16 v[48:49], v12 offset:47104
    ds_read_b64_tr_b16 v[50:51], v12 offset:47360
    s_add_u32 m0, s57, 16384
    s_add_u32 s62, s58, 4096
    buffer_load_dwordx4 v2, s[40:43], s62 offen sc1 lds
    s_waitcnt lgkmcnt(4)
    v_mfma_f32_32x32x16_bf16 v[112:127], v[56:59], v[244:247], v[112:127]
    ds_read_b64_tr_b16 v[52:53], v13 offset:47104
    ds_read_b64_tr_b16 v[54:55], v13 offset:47360
    s_add_u32 m0, s57, 24576
    s_add_u32 s62, s59, 4096
    buffer_load_dwordx4 v2, s[40:43], s62 offen sc1 lds
    s_waitcnt lgkmcnt(4)
    v_mfma_f32_32x32x16_bf16 v[32:47], v[60:63], v[244:247], v[32:47]
    ds_read_b64_tr_b16 v[56:57], v12 offset:48128
    ds_read_b64_tr_b16 v[58:59], v12 offset:48384
    s_add_u32 m0, s57, 32768
    s_add_u32 s62, s58, 8192
    buffer_load_dwordx4 v2, s[40:43], s62 offen sc1 lds
    s_waitcnt lgkmcnt(4)
    v_mfma_f32_32x32x16_bf16 v[112:127], v[48:51], v[248:251], v[112:127]
    ds_read_b64_tr_b16 v[60:61], v13 offset:48128
    ds_read_b64_tr_b16 v[62:63], v13 offset:48384
    s_add_u32 m0, s57, 40960
    s_add_u32 s62, s59, 8192
    buffer_load_dwordx4 v2, s[40:43], s62 offen sc1 lds
    s_waitcnt lgkmcnt(4)
    v_mfma_f32_32x32x16_bf16 v[32:47], v[52:55], v[248:251], v[32:47]
    s_add_u32 m0, s57, 49152
    s_add_u32 s62, s58, 12288
    buffer_load_dwordx4 v2, s[40:43], s62 offen sc1 lds
    s_waitcnt lgkmcnt(2)
    v_mfma_f32_32x32x16_bf16 v[112:127], v[56:59], v[252:255], v[112:127]
    s_add_u32 m0, s57, 57344
    s_add_u32 s62, s59, 12288
    buffer_load_dwordx4 v2, s[40:43], s62 offen sc1 lds
    s_waitcnt lgkmcnt(0)
    v_mfma_f32_32x32x16_bf16 v[32:47], v[60:63], v[252:255], v[32:47]
    s_nop 11
    v_mul_f32 v112, v29, v112
    v_mul_f32 v113, v29, v113
    v_mul_f32 v114, v29, v114
    v_mul_f32 v115, v29, v115
    v_exp_f32 v112, v112
    v_exp_f32 v113, v113
    v_exp_f32 v114, v114
    v_exp_f32 v115, v115
    v_add_f32 v112, 1.0, v112
    v_add_f32 v113, 1.0, v113
    v_add_f32 v114, 1.0, v114
    v_add_f32 v115, 1.0, v115
    v_rcp_f32 v112, v112
    v_rcp_f32 v113, v113
    v_rcp_f32 v114, v114
    v_rcp_f32 v115, v115
    v_mul_f32 v112, v112, v120
    v_mul_f32 v113, v113, v121
    v_mul_f32 v114, v114, v122
    v_mul_f32 v115, v115, v123
    v_mul_f32 v116, v29, v116
    v_mul_f32 v117, v29, v117
    v_mul_f32 v118, v29, v118
    v_mul_f32 v119, v29, v119
    v_exp_f32 v116, v116
    v_exp_f32 v117, v117
    v_exp_f32 v118, v118
    v_exp_f32 v119, v119
    v_add_f32 v116, 1.0, v116
    v_add_f32 v117, 1.0, v117
    v_add_f32 v118, 1.0, v118
    v_add_f32 v119, 1.0, v119
    v_rcp_f32 v116, v116
    v_rcp_f32 v117, v117
    v_rcp_f32 v118, v118
    v_rcp_f32 v119, v119
    v_mul_f32 v116, v116, v124
    v_mul_f32 v117, v117, v125
    v_mul_f32 v118, v118, v126
    v_mul_f32 v119, v119, v127
    v_cvt_pk_bf16_f32 v144, v112, v113
    v_cvt_pk_bf16_f32 v145, v114, v115
    v_cvt_pk_bf16_f32 v146, v116, v117
    v_cvt_pk_bf16_f32 v147, v118, v119
    v_mul_f32 v32, v29, v32
    v_mul_f32 v33, v29, v33
    v_mul_f32 v34, v29, v34
    v_mul_f32 v35, v29, v35
    v_exp_f32 v32, v32
    v_exp_f32 v33, v33
    v_exp_f32 v34, v34
    v_exp_f32 v35, v35
    v_add_f32 v32, 1.0, v32
    v_add_f32 v33, 1.0, v33
    v_add_f32 v34, 1.0, v34
    v_add_f32 v35, 1.0, v35
    v_rcp_f32 v32, v32
    v_rcp_f32 v33, v33
    v_rcp_f32 v34, v34
    v_rcp_f32 v35, v35
    v_mul_f32 v32, v32, v40
    v_mul_f32 v33, v33, v41
    v_mul_f32 v34, v34, v42
    v_mul_f32 v35, v35, v43
    v_mul_f32 v36, v29, v36
    v_mul_f32 v37, v29, v37
    v_mul_f32 v38, v29, v38
    v_mul_f32 v39, v29, v39
    v_exp_f32 v36, v36
    v_exp_f32 v37, v37
    v_exp_f32 v38, v38
    v_exp_f32 v39, v39
    v_add_f32 v36, 1.0, v36
    v_add_f32 v37, 1.0, v37
    v_add_f32 v38, 1.0, v38
    v_add_f32 v39, 1.0, v39
    v_rcp_f32 v36, v36
    v_rcp_f32 v37, v37
    v_rcp_f32 v38, v38
    v_rcp_f32 v39, v39
    v_mul_f32 v36, v36, v44
    v_mul_f32 v37, v37, v45
    v_mul_f32 v38, v38, v46
    v_mul_f32 v39, v39, v47
    v_cvt_pk_bf16_f32 v148, v32, v33
    v_cvt_pk_bf16_f32 v149, v34, v35
    v_cvt_pk_bf16_f32 v150, v36, v37
    v_cvt_pk_bf16_f32 v151, v38, v39
    s_mov_b32 s70, s66
    s_mov_b32 s71, 0x7f000000
    s_mov_b32 s72, 0x7f000000
    buffer_store_dwordx4 v[144:147], v2, s[40:43], s66 offen sc1
    buffer_store_dwordx4 v[148:151], v2, s[40:43], s66 offen offset:1024 sc1
    s_lshl_b32 s62, s53, 12
    v_add_u32 v4, s62, v2
    v_lshrrev_b32 v240, 5, v1
    v_and_b32 v3, 15, v1
    v_lshlrev_b32 v3, 4, v3
    v_lshl_add_u32 v3, v240, 8, v3
    v_add_u32 v3, 0x2000, v3
    v_add_u32 v5, s62, v3
    v_and_b32 v240, 27, v1
    v_cmp_eq_u32 vcc, 16, v240
    v_mov_b32 v240, 0x3f803f80
    v_mov_b32 v241, 0
    v_cndmask_b32 v240, v241, v240, vcc
    v_mov_b32 v24, v240
    v_mov_b32 v25, v240
    v_mov_b32 v26, v240
    v_mov_b32 v27, v240
    v_mov_b32 v28, v240
    v_mov_b32 v29, v240
    v_mov_b32 v30, v240
    v_mov_b32 v31, v240
    v_mov_b32 v32, v240
    v_mov_b32 v33, v240
    v_mov_b32 v34, v240
    v_mov_b32 v35, v240
    v_mov_b32 v36, v240
    v_mov_b32 v37, v240
    v_mov_b32 v38, v240
    v_mov_b32 v39, v240
    v_mov_b32 v112, 0
    v_mov_b32 v113, 0
    v_mov_b32 v114, 0
    v_mov_b32 v115, 0
    v_mov_b32 v116, 0
    v_mov_b32 v117, 0
    v_mov_b32 v118, 0
    v_mov_b32 v119, 0
    v_mov_b32 v120, 0
    v_mov_b32 v121, 0
    v_mov_b32 v122, 0
    v_mov_b32 v123, 0
    v_mov_b32 v124, 0
    v_mov_b32 v125, 0
    v_mov_b32 v126, 0
    v_mov_b32 v127, 0
    v_mov_b32 v128, 0
    v_mov_b32 v129, 0
    v_mov_b32 v130, 0
    v_mov_b32 v131, 0
    v_mov_b32 v132, 0
    v_mov_b32 v133, 0
    v_mov_b32 v134, 0
    v_mov_b32 v135, 0
    v_mov_b32 v136, 0
    v_mov_b32 v137, 0
    v_mov_b32 v138, 0
    v_mov_b32 v139, 0
    v_mov_b32 v140, 0
    v_mov_b32 v141, 0
    v_mov_b32 v142, 0
    v_mov_b32 v143, 0
    s_mov_b32 s60, 0x0000ffff
    s_mov_b32 s61, 0x0000ffff
    s_waitcnt vmcnt(6)
G_DONE:
    s_lshr_b32 s62, s49, 2
    v_lshlrev_b32 v7, 3, v1
    v_add_u32 v7, s62, v7
    s_lshr_b32 s62, s50, 1
    s_add_u32 s62, s62, 4
    s_lshl_b32 s62, s62, 3
    v_bfe_u32 v6, v1, 3, 2
    v_lshlrev_b32 v6, 6, v6
    v_and_b32 v240, 7, v1
    v_add3_u32 v6, v6, v240, s62
    v_cmp_lt_u32 vcc, 31, v1
    s_nop 1
    v_cndmask_b32 v7, v7, v6, vcc
    v_lshlrev_b32 v7, 7, v7
    v_add_u32 v7, 23068672, v7
    s_lshr_b32 s62, s48, 1
    s_mul_i32 s63, s62, 28
    s_mul_i32 s64, s49, 224
    s_add_u32 s64, s64, s63
    s_lshl_b32 s64, s64, 10
    s_add_u32 s64, s64, 8388608
    s_add_u32 s65, s64, 114688
    s_lshl_b32 s66, s63, 4
    s_lshl_b32 s67, s50, 1
    s_add_u32 s66, s66, s67
    s_and_b32 s67, s48, 1
    s_add_u32 s66, s66, s67
    s_lshl_b32 s66, s66, 10
    s_add_u32 s66, s66, 16777216
    v_mov_b32 v8, v64
    v_mov_b32 v9, v65
    v_mov_b32 v10, v66
    v_mov_b32 v11, v67
    v_mov_b32 v12, v68
    v_mov_b32 v13, v69
    v_mov_b32 v14, v70
    v_mov_b32 v15, v71
    s_barrier
    ds_read_b128 v[240:243], v2
    ds_read_b128 v[16:19], v4 offset:0
    s_mov_b64 exec, s[60:61]
    ds_read_b128 v[24:27], v5 offset:0
    ds_read_b128 v[28:31], v5 offset:512
    s_mov_b64 exec, -1
    s_waitcnt lgkmcnt(3)
    v_mfma_f32_32x32x16_bf16 v[80:95], v[240:243], v[8:11], 0
    v_mfma_f32_32x32x16_bf16 v[96:111], v[240:243], v[12:15], 0
    s_nop 14
    v_max3_f32 v244, v80, v81, v82
    v_max3_f32 v244, v244, v83, v84
    v_max3_f32 v244, v244, v85, v86
    v_max3_f32 v244, v244, v87, v88
    v_max3_f32 v244, v244, v89, v90
    v_max3_f32 v244, v244, v91, v92
    v_max3_f32 v244, v244, v93, v94
    v_max_f32 v244, v244, v95
    v_mov_b32 v245, v244
    s_nop 1
    v_permlane32_swap_b32 v244, v245
    s_nop 1
    v_max_f32 v244, v244, v245
    v_sub_f32 v48, 0, v244
    v_sub_f32 v49, 0, v244
    v_sub_f32 v50, 0, v244
    v_sub_f32 v51, 0, v244
    v_sub_f32 v52, 0, v244
    v_sub_f32 v53, 0, v244
    v_sub_f32 v54, 0, v244
    v_sub_f32 v55, 0, v244
    v_sub_f32 v56, 0, v244
    v_sub_f32 v57, 0, v244
    v_sub_f32 v58, 0, v244
    v_sub_f32 v59, 0, v244
    v_sub_f32 v60, 0, v244
    v_sub_f32 v61, 0, v244
    v_sub_f32 v62, 0, v244
    v_sub_f32 v63, 0, v244
    v_max3_f32 v246, v96, v97, v98
    v_max3_f32 v246, v246, v99, v100
    v_max3_f32 v246, v246, v101, v102
    v_max3_f32 v246, v246, v103, v104
    v_max3_f32 v246, v246, v105, v106
    v_max3_f32 v246, v246, v107, v108
    v_max3_f32 v246, v246, v109, v110
    v_max_f32 v246, v246, v111
    v_mov_b32 v247, v246
    s_nop 1
    v_permlane32_swap_b32 v246, v247
    s_nop 1
    v_max_f32 v246, v246, v247
    v_sub_f32 v64, 0, v246
    v_sub_f32 v65, 0, v246
    v_sub_f32 v66, 0, v246
    v_sub_f32 v67, 0, v246
    v_sub_f32 v68, 0, v246
    v_sub_f32 v69, 0, v246
    v_sub_f32 v70, 0, v246
    v_sub_f32 v71, 0, v246
    v_sub_f32 v72, 0, v246
    v_sub_f32 v73, 0, v246
    v_sub_f32 v74, 0, v246
    v_sub_f32 v75, 0, v246
    v_sub_f32 v76, 0, v246
    v_sub_f32 v77, 0, v246
    v_sub_f32 v78, 0, v246
    v_sub_f32 v79, 0, v246
    s_waitcnt lgkmcnt(0)
    v_mfma_f32_32x32x16_bf16 v[80:95], v[16:19], v[8:11], v[48:63]
    ds_read_b128 v[20:23], v4 offset:1024
    s_nop 11
    v_exp_f32 v80, v80
    v_exp_f32 v81, v81
    v_mfma_f32_32x32x16_bf16 v[96:111], v[16:19], v[12:15], v[64:79]
    v_exp_f32 v82, v82
    v_cvt_pk_bf16_f32 v40, v80, v81
    v_exp_f32 v83, v83
    s_add_u32 m0, s57, 65536
    s_add_u32 s62, s58, 16384
    buffer_load_dwordx4 v2, s[40:43], s62 offen sc1 lds
    v_exp_f32 v84, v84
    v_cvt_pk_bf16_f32 v41, v82, v83
    v_exp_f32 v85, v85
    s_mov_b64 exec, s[60:61]
    ds_read_b128 v[32:35], v5 offset:1024
    ds_read_b128 v[36:39], v5 offset:1536
    s_mov_b64 exec, -1
    v_exp_f32 v86, v86
    v_cvt_pk_bf16_f32 v42, v84, v85
    v_exp_f32 v87, v87
    s_add_u32 m0, s57, 73728
    s_add_u32 s62, s59, 16384
    buffer_load_dwordx4 v2, s[40:43], s62 offen sc1 lds
    v_exp_f32 v88, v88
    v_cvt_pk_bf16_f32 v43, v86, v87
    v_exp_f32 v89, v89
    v_exp_f32 v90, v90
    v_cvt_pk_bf16_f32 v44, v88, v89
    v_mfma_f32_32x32x16_bf16 v[112:127], v[24:27], v[40:43], v[112:127]
    v_exp_f32 v91, v91
    v_exp_f32 v92, v92
    v_cvt_pk_bf16_f32 v45, v90, v91
    s_add_u32 m0, s57, 81920
    s_add_u32 s62, s58, 20480
    buffer_load_dwordx4 v2, s[40:43], s62 offen sc1 lds
    v_exp_f32 v93, v93
    v_exp_f32 v94, v94
    v_exp_f32 v95, v95
    v_cvt_pk_bf16_f32 v46, v92, v93
    v_cvt_pk_bf16_f32 v47, v94, v95
    v_exp_f32 v96, v96
    v_exp_f32 v97, v97
    s_waitcnt lgkmcnt(0)
    v_mfma_f32_32x32x16_bf16 v[80:95], v[20:23], v[8:11], v[48:63]
    ds_read_b128 v[16:19], v4 offset:2048
    v_exp_f32 v98, v98
    v_cvt_pk_bf16_f32 v40, v96, v97
    v_exp_f32 v99, v99
    s_add_u32 m0, s57, 90112
    s_add_u32 s62, s59, 20480
    buffer_load_dwordx4 v2, s[40:43], s62 offen sc1 lds
    v_exp_f32 v100, v100
    v_cvt_pk_bf16_f32 v41, v98, v99
    v_exp_f32 v101, v101
    v_mfma_f32_32x32x16_bf16 v[112:127], v[28:31], v[44:47], v[112:127]
    v_exp_f32 v102, v102
    v_cvt_pk_bf16_f32 v42, v100, v101
    v_exp_f32 v103, v103
    s_add_u32 m0, s57, 98304
    s_add_u32 s62, s58, 24576
    buffer_load_dwordx4 v2, s[40:43], s62 offen sc1 lds
    v_exp_f32 v104, v104
    v_cvt_pk_bf16_f32 v43, v102, v103
    v_exp_f32 v105, v105
    v_exp_f32 v106, v106
    v_cvt_pk_bf16_f32 v44, v104, v105
    v_mfma_f32_32x32x16_bf16 v[128:143], v[24:27], v[40:43], v[128:143]
    v_exp_f32 v107, v107
    v_exp_f32 v108, v108
    v_cvt_pk_bf16_f32 v45, v106, v107
    s_add_u32 m0, s57, 106496
    s_add_u32 s62, s59, 24576
    buffer_load_dwordx4 v2, s[40:43], s62 offen sc1 lds
    v_exp_f32 v109, v109
    v_exp_f32 v110, v110
    v_exp_f32 v111, v111
    v_cvt_pk_bf16_f32 v46, v108, v109
    v_cvt_pk_bf16_f32 v47, v110, v111
    v_exp_f32 v80, v80
    v_exp_f32 v81, v81
    v_mfma_f32_32x32x16_bf16 v[96:111], v[20:23], v[12:15], v[64:79]
    v_exp_f32 v82, v82
    v_cvt_pk_bf16_f32 v40, v80, v81
    v_exp_f32 v83, v83
    s_add_u32 m0, s57, 114688
    s_add_u32 s62, s58, 28672
    buffer_load_dwordx4 v2, s[40:43], s62 offen sc1 lds
    v_exp_f32 v84, v84
    v_cvt_pk_bf16_f32 v41, v82, v83
    v_exp_f32 v85, v85
    v_mfma_f32_32x32x16_bf16 v[128:143], v[28:31], v[44:47], v[128:143]
    s_mov_b64 exec, s[60:61]
    ds_read_b128 v[24:27], v5 offset:2048
    ds_read_b128 v[28:31], v5 offset:2560
    s_mov_b64 exec, -1
    v_exp_f32 v86, v86
    v_cvt_pk_bf16_f32 v42, v84, v85
    v_exp_f32 v87, v87
    s_add_u32 m0, s57, 122880
    s_add_u32 s62, s59, 28672
    buffer_load_dwordx4 v2, s[40:43], s62 offen sc1 lds
    v_exp_f32 v88, v88
    v_cvt_pk_bf16_f32 v43, v86, v87
    v_exp_f32 v89, v89
    v_exp_f32 v90, v90
    v_cvt_pk_bf16_f32 v44, v88, v89
    v_mfma_f32_32x32x16_bf16 v[112:127], v[32:35], v[40:43], v[112:127]
    v_exp_f32 v91, v91
    v_exp_f32 v92, v92
    v_cvt_pk_bf16_f32 v45, v90, v91
    v_exp_f32 v93, v93
    v_exp_f32 v94, v94
    v_exp_f32 v95, v95
    v_cvt_pk_bf16_f32 v46, v92, v93
    v_cvt_pk_bf16_f32 v47, v94, v95
    v_exp_f32 v96, v96
    v_exp_f32 v97, v97
    s_waitcnt lgkmcnt(0)
    v_mfma_f32_32x32x16_bf16 v[80:95], v[16:19], v[8:11], v[48:63]
    ds_read_b128 v[20:23], v4 offset:3072
    v_exp_f32 v98, v98
    v_cvt_pk_bf16_f32 v40, v96, v97
    v_exp_f32 v99, v99
    v_exp_f32 v100, v100
    v_cvt_pk_bf16_f32 v41, v98, v99
    v_exp_f32 v101, v101
    v_mfma_f32_32x32x16_bf16 v[112:127], v[36:39], v[44:47], v[112:127]
    v_exp_f32 v102, v102
    v_cvt_pk_bf16_f32 v42, v100, v101
    v_exp_f32 v103, v103
    v_exp_f32 v104, v104
    v_cvt_pk_bf16_f32 v43, v102, v103
    v_exp_f32 v105, v105
    v_exp_f32 v106, v106
    v_cvt_pk_bf16_f32 v44, v104, v105
    v_mfma_f32_32x32x16_bf16 v[128:143], v[32:35], v[40:43], v[128:143]
    v_exp_f32 v107, v107
    v_exp_f32 v108, v108
    v_cvt_pk_bf16_f32 v45, v106, v107
    v_exp_f32 v109, v109
    v_exp_f32 v110, v110
    v_exp_f32 v111, v111
    v_cvt_pk_bf16_f32 v46, v108, v109
    v_cvt_pk_bf16_f32 v47, v110, v111
    s_waitcnt vmcnt(8)
    s_barrier
    v_lshlrev_b32 v249, 2, v1
    s_cmp_lg_u32 s48, 0
    s_cbranch_scc1 A_FL3
    s_add_u32 s37, s39, 3
    v_mov_b32 v0, s37
    s_mov_b32 exec_hi, 0
    buffer_store_dword v0, v249, s[40:43], s36 offen sc1
    s_mov_b32 exec_hi, -1
A_FL3:
    v_exp_f32 v80, v80
    v_exp_f32 v81, v81
    v_mfma_f32_32x32x16_bf16 v[96:111], v[16:19], v[12:15], v[64:79]
    v_exp_f32 v82, v82
    v_cvt_pk_bf16_f32 v40, v80, v81
    v_exp_f32 v83, v83
    v_exp_f32 v84, v84
    v_cvt_pk_bf16_f32 v41, v82, v83
    v_exp_f32 v85, v85
    v_mfma_f32_32x32x16_bf16 v[128:143], v[36:39], v[44:47], v[128:143]
    s_mov_b64 exec, s[60:61]
    ds_read_b128 v[32:35], v5 offset:3072
    ds_read_b128 v[36:39], v5 offset:3584
    s_mov_b64 exec, -1
    v_exp_f32 v86, v86
    v_cvt_pk_bf16_f32 v42, v84, v85
    v_exp_f32 v87, v87
    v_exp_f32 v88, v88
    v_cvt_pk_bf16_f32 v43, v86, v87
    v_exp_f32 v89, v89
    v_exp_f32 v90, v90
    v_cvt_pk_bf16_f32 v44, v88, v89
    v_mfma_f32_32x32x16_bf16 v[112:127], v[24:27], v[40:43], v[112:127]
    v_exp_f32 v91, v91
    v_exp_f32 v92, v92
    v_cvt_pk_bf16_f32 v45, v90, v91
    v_exp_f32 v93, v93
    v_exp_f32 v94, v94
    v_exp_f32 v95, v95
    v_cvt_pk_bf16_f32 v46, v92, v93
    v_cvt_pk_bf16_f32 v47, v94, v95
    v_exp_f32 v96, v96
    v_exp_f32 v97, v97
    s_waitcnt lgkmcnt(0)
    v_mfma_f32_32x32x16_bf16 v[80:95], v[20:23], v[8:11], v[48:63]
    ds_read_b128 v[16:19], v4 offset:16384
    v_exp_f32 v98, v98
    v_cvt_pk_bf16_f32 v40, v96, v97
    v_exp_f32 v99, v99
    v_exp_f32 v100, v100
    v_cvt_pk_bf16_f32 v41, v98, v99
    v_exp_f32 v101, v101
    v_mfma_f32_32x32x16_bf16 v[112:127], v[28:31], v[44:47], v[112:127]
    v_exp_f32 v102, v102
    v_cvt_pk_bf16_f32 v42, v100, v101
    v_exp_f32 v103, v103
    v_exp_f32 v104, v104
    v_cvt_pk_bf16_f32 v43, v102, v103
    v_exp_f32 v105, v105
    v_exp_f32 v106, v106
    v_cvt_pk_bf16_f32 v44, v104, v105
    v_mfma_f32_32x32x16_bf16 v[128:143], v[24:27], v[40:43], v[128:143]
    v_exp_f32 v107, v107
    v_exp_f32 v108, v108
    v_cvt_pk_bf16_f32 v45, v106, v107
    v_exp_f32 v109, v109
    v_exp_f32 v110, v110
    v_exp_f32 v111, v111
    v_cvt_pk_bf16_f32 v46, v108, v109
    v_cvt_pk_bf16_f32 v47, v110, v111
    v_exp_f32 v80, v80
    v_exp_f32 v81, v81
    v_mfma_f32_32x32x16_bf16 v[96:111], v[20:23], v[12:15], v[64:79]
    v_exp_f32 v82, v82
    v_cvt_pk_bf16_f32 v40, v80, v81
    v_exp_f32 v83, v83
    v_exp_f32 v84, v84
    v_cvt_pk_bf16_f32 v41, v82, v83
    v_exp_f32 v85, v85
    v_mfma_f32_32x32x16_bf16 v[128:143], v[28:31], v[44:47], v[128:143]
    s_mov_b64 exec, s[60:61]
    ds_read_b128 v[24:27], v5 offset:16384
    ds_read_b128 v[28:31], v5 offset:16896
    s_mov_b64 exec, -1
    v_exp_f32 v86, v86
    v_cvt_pk_bf16_f32 v42, v84, v85
    v_exp_f32 v87, v87
    v_exp_f32 v88, v88
    v_cvt_pk_bf16_f32 v43, v86, v87
    v_exp_f32 v89, v89
    v_exp_f32 v90, v90
    v_cvt_pk_bf16_f32 v44, v88, v89
    v_mfma_f32_32x32x16_bf16 v[112:127], v[32:35], v[40:43], v[112:127]
    v_exp_f32 v91, v91
    v_exp_f32 v92, v92
    v_cvt_pk_bf16_f32 v45, v90, v91
    v_exp_f32 v93, v93
    v_exp_f32 v94, v94
    v_exp_f32 v95, v95
    v_cvt_pk_bf16_f32 v46, v92, v93
    v_cvt_pk_bf16_f32 v47, v94, v95
    v_exp_f32 v96, v96
    v_exp_f32 v97, v97
    s_waitcnt lgkmcnt(0)
    v_mfma_f32_32x32x16_bf16 v[80:95], v[16:19], v[8:11], v[48:63]
    ds_read_b128 v[20:23], v4 offset:17408
    v_exp_f32 v98, v98
    v_cvt_pk_bf16_f32 v40, v96, v97
    v_exp_f32 v99, v99
    v_exp_f32 v100, v100
    v_cvt_pk_bf16_f32 v41, v98, v99
    v_exp_f32 v101, v101
    v_mfma_f32_32x32x16_bf16 v[112:127], v[36:39], v[44:47], v[112:127]
    v_exp_f32 v102, v102
    v_cvt_pk_bf16_f32 v42, v100, v101
    v_exp_f32 v103, v103
    v_exp_f32 v104, v104
    v_cvt_pk_bf16_f32 v43, v102, v103
    v_exp_f32 v105, v105
    v_exp_f32 v106, v106
    v_cvt_pk_bf16_f32 v44, v104, v105
    v_mfma_f32_32x32x16_bf16 v[128:143], v[32:35], v[40:43], v[128:143]
    v_exp_f32 v107, v107
    v_exp_f32 v108, v108
    v_cvt_pk_bf16_f32 v45, v106, v107
    v_exp_f32 v109, v109
    v_exp_f32 v110, v110
    v_exp_f32 v111, v111
    v_cvt_pk_bf16_f32 v46, v108, v109
    v_cvt_pk_bf16_f32 v47, v110, v111
    v_add_u32 v4, 16384, v4
    v_add_u32 v5, 16384, v5
    v_mov_b32 v144, 0
    v_mov_b32 v145, 0
    v_mov_b32 v146, 0
    v_mov_b32 v147, 0
    v_mov_b32 v148, 0
    v_mov_b32 v149, 0
    v_mov_b32 v150, 0
    v_mov_b32 v151, 0
    v_mov_b32 v152, 0
    v_mov_b32 v153, 0
    v_mov_b32 v154, 0
    v_mov_b32 v155, 0
    v_mov_b32 v156, 0
    v_mov_b32 v157, 0
    v_mov_b32 v158, 0
    v_mov_b32 v159, 0
    v_mov_b32 v160, 0
    v_mov_b32 v161, 0
    v_mov_b32 v162, 0
    v_mov_b32 v163, 0
    v_mov_b32 v164, 0
    v_mov_b32 v165, 0
    v_mov_b32 v166, 0
    v_mov_b32 v167, 0
    v_mov_b32 v168, 0
    v_mov_b32 v169, 0
    v_mov_b32 v170, 0
    v_mov_b32 v171, 0
    v_mov_b32 v172, 0
    v_mov_b32 v173, 0
    v_mov_b32 v174, 0
    v_mov_b32 v175, 0
    v_exp_f32 v80, v80
    v_exp_f32 v81, v81
    v_mfma_f32_32x32x16_bf16 v[96:111], v[16:19], v[12:15], v[64:79]
    v_exp_f32 v82, v82
    v_cvt_pk_bf16_f32 v40, v80, v81
    v_exp_f32 v83, v83
    v_exp_f32 v84, v84
    v_cvt_pk_bf16_f32 v41, v82, v83
    v_exp_f32 v85, v85
    v_mfma_f32_32x32x16_bf16 v[128:143], v[36:39], v[44:47], v[128:143]
    s_mov_b64 exec, s[60:61]
    ds_read_b128 v[32:35], v5 offset:1024
    ds_read_b128 v[36:39], v5 offset:1536
    s_mov_b64 exec, -1
    v_exp_f32 v86, v86
    v_cvt_pk_bf16_f32 v42, v84, v85
    v_exp_f32 v87, v87
    v_exp_f32 v88, v88
    v_cvt_pk_bf16_f32 v43, v86, v87
    v_exp_f32 v89, v89
    v_exp_f32 v90, v90
    v_cvt_pk_bf16_f32 v44, v88, v89
    v_mfma_f32_32x32x16_bf16 v[112:127], v[24:27], v[40:43], v[112:127]
    v_exp_f32 v91, v91
    v_exp_f32 v92, v92
    v_cvt_pk_bf16_f32 v45, v90, v91
    v_exp_f32 v93, v93
    v_exp_f32 v94, v94
    v_exp_f32 v95, v95
    v_cvt_pk_bf16_f32 v46, v92, v93
    v_cvt_pk_bf16_f32 v47, v94, v95
    v_exp_f32 v96, v96
    v_exp_f32 v97, v97
    s_waitcnt lgkmcnt(0)
    v_mfma_f32_32x32x16_bf16 v[80:95], v[20:23], v[8:11], v[48:63]
    ds_read_b128 v[16:19], v4 offset:2048
    v_exp_f32 v98, v98
    v_cvt_pk_bf16_f32 v40, v96, v97
    v_exp_f32 v99, v99
    s_cmp_lg_u32 s48, 0
    s_cbranch_scc1 A_NOPOLL3
    buffer_load_dword v6, v7, s[40:43], 0 offen sc1
    A_NOPOLL3:
    v_exp_f32 v100, v100
    v_cvt_pk_bf16_f32 v41, v98, v99
    v_exp_f32 v101, v101
    v_mfma_f32_32x32x16_bf16 v[112:127], v[28:31], v[44:47], v[112:127]
    v_exp_f32 v102, v102
    v_cvt_pk_bf16_f32 v42, v100, v101
    v_exp_f32 v103, v103
    v_exp_f32 v104, v104
    v_cvt_pk_bf16_f32 v43, v102, v103
    v_exp_f32 v105, v105
    v_exp_f32 v106, v106
    v_cvt_pk_bf16_f32 v44, v104, v105
    v_mfma_f32_32x32x16_bf16 v[128:143], v[24:27], v[40:43], v[128:143]
    v_exp_f32 v107, v107
    v_exp_f32 v108, v108
    v_cvt_pk_bf16_f32 v45, v106, v107
    v_exp_f32 v109, v109
    v_exp_f32 v110, v110
    v_exp_f32 v111, v111
    v_cvt_pk_bf16_f32 v46, v108, v109
    v_cvt_pk_bf16_f32 v47, v110, v111
    v_exp_f32 v80, v80
    v_exp_f32 v81, v81
    v_mfma_f32_32x32x16_bf16 v[96:111], v[20:23], v[12:15], v[64:79]
    v_exp_f32 v82, v82
    v_cvt_pk_bf16_f32 v40, v80, v81
    v_exp_f32 v83, v83
    v_exp_f32 v84, v84
    v_cvt_pk_bf16_f32 v41, v82, v83
    v_exp_f32 v85, v85
    v_mfma_f32_32x32x16_bf16 v[128:143], v[28:31], v[44:47], v[128:143]
    s_mov_b64 exec, s[60:61]
    ds_read_b128 v[24:27], v5 offset:2048
    ds_read_b128 v[28:31], v5 offset:2560
    s_mov_b64 exec, -1
    v_exp_f32 v86, v86
    v_cvt_pk_bf16_f32 v42, v84, v85
    v_exp_f32 v87, v87
    v_exp_f32 v88, v88
    v_cvt_pk_bf16_f32 v43, v86, v87
    v_exp_f32 v89, v89
    v_exp_f32 v90, v90
    v_cvt_pk_bf16_f32 v44, v88, v89
    v_mfma_f32_32x32x16_bf16 v[112:127], v[32:35], v[40:43], v[112:127]
    v_exp_f32 v91, v91
    v_exp_f32 v92, v92
    v_cvt_pk_bf16_f32 v45, v90, v91
    v_exp_f32 v93, v93
    v_exp_f32 v94, v94
    v_exp_f32 v95, v95
    v_cvt_pk_bf16_f32 v46, v92, v93
    v_cvt_pk_bf16_f32 v47, v94, v95
    s_waitcnt vmcnt(0)
    s_cmp_lg_u32 s48, 0
    s_cbranch_scc1 A_P3_OK
    s_mov_b32 s37, 262144
    s_add_u32 s38, s39, 3
A_P3_CHK:
    v_subrev_u32 v6, s38, v6
    v_cmp_lt_u32 vcc, 3, v6
    s_cmp_eq_u64 vcc, 0
    s_cbranch_scc1 A_P3_OK
    s_sub_u32 s37, s37, 1
    s_cmp_eq_u32 s37, 0
    s_cbranch_scc1 A_P3_OK
    s_sleep 1
    buffer_load_dword v6, v7, s[40:43], 0 offen sc1
    s_waitcnt vmcnt(0)
    s_branch A_P3_CHK
A_P3_OK:
    s_barrier
    v_exp_f32 v96, v96
    v_exp_f32 v97, v97
    s_waitcnt lgkmcnt(0)
    v_mfma_f32_32x32x16_bf16 v[80:95], v[16:19], v[8:11], v[48:63]
    ds_read_b128 v[20:23], v4 offset:3072
    v_exp_f32 v98, v98
    v_cvt_pk_bf16_f32 v40, v96, v97
    v_exp_f32 v99, v99
    buffer_load_dwordx4 v[176:179], v2, s[40:43], s66 offen sc1
    s_add_u32 s66, s66, 16384
    v_exp_f32 v100, v100
    v_cvt_pk_bf16_f32 v41, v98, v99
    v_exp_f32 v101, v101
    v_mfma_f32_32x32x16_bf16 v[112:127], v[36:39], v[44:47], v[112:127]
    v_exp_f32 v102, v102
    v_cvt_pk_bf16_f32 v42, v100, v101
    v_exp_f32 v103, v103
    buffer_load_dwordx4 v[180:183], v2, s[40:43], s64 offen offset:0 sc1
    v_exp_f32 v104, v104
    v_cvt_pk_bf16_f32 v43, v102, v103
    v_exp_f32 v105, v105
    v_exp_f32 v106, v106
    v_cvt_pk_bf16_f32 v44, v104, v105
    v_mfma_f32_32x32x16_bf16 v[128:143], v[32:35], v[40:43], v[128:143]
    v_exp_f32 v107, v107
    v_exp_f32 v108, v108
    v_cvt_pk_bf16_f32 v45, v106, v107
    buffer_load_dwordx4 v[184:187], v2, s[40:43], s65 offen offset:0 sc1
    v_exp_f32 v109, v109
    v_exp_f32 v110, v110
    v_exp_f32 v111, v111
    v_cvt_pk_bf16_f32 v46, v108, v109
    v_cvt_pk_bf16_f32 v47, v110, v111
    v_exp_f32 v80, v80
    v_exp_f32 v81, v81
    v_mfma_f32_32x32x16_bf16 v[96:111], v[16:19], v[12:15], v[64:79]
    v_exp_f32 v82, v82
    v_cvt_pk_bf16_f32 v40, v80, v81
    v_exp_f32 v83, v83
    buffer_load_dwordx4 v[188:191], v2, s[40:43], s66 offen sc1
    s_add_u32 s66, s66, 16384
    v_exp_f32 v84, v84
    v_cvt_pk_bf16_f32 v41, v82, v83
    v_exp_f32 v85, v85
    v_mfma_f32_32x32x16_bf16 v[128:143], v[36:39], v[44:47], v[128:143]
    s_mov_b64 exec, s[60:61]
    ds_read_b128 v[32:35], v5 offset:3072
    ds_read_b128 v[36:39], v5 offset:3584
    s_mov_b64 exec, -1
    v_exp_f32 v86, v86
    v_cvt_pk_bf16_f32 v42, v84, v85
    v_exp_f32 v87, v87
    buffer_load_dwordx4 v[192:195], v2, s[40:43], s64 offen offset:1024 sc1
    v_exp_f32 v88, v88
    v_cvt_pk_bf16_f32 v43, v86, v87
    v_exp_f32 v89, v89
    v_exp_f32 v90, v90
    v_cvt_pk_bf16_f32 v44, v88, v89
    v_mfma_f32_32x32x16_bf16 v[112:127], v[24:27], v[40:43], v[112:127]
    v_exp_f32 v91, v91
    v_exp_f32 v92, v92
    v_cvt_pk_bf16_f32 v45, v90, v91
    buffer_load_dwordx4 v[196:199], v2, s[40:43], s65 offen offset:1024 sc1
    v_exp_f32 v93, v93
    v_exp_f32 v94, v94
    v_exp_f32 v95, v95
    v_cvt_pk_bf16_f32 v46, v92, v93
    v_cvt_pk_bf16_f32 v47, v94, v95
    v_exp_f32 v96, v96
    v_exp_f32 v97, v97
    s_waitcnt lgkmcnt(0)
    v_mfma_f32_32x32x16_bf16 v[80:95], v[20:23], v[8:11], v[48:63]
    ds_read_b128 v[16:19], v4 offset:16384
    v_exp_f32 v98, v98
    v_cvt_pk_bf16_f32 v40, v96, v97
    v_exp_f32 v99, v99
    buffer_load_dwordx4 v[200:203], v2, s[40:43], s66 offen sc1
    s_add_u32 s66, s66, 16384
    v_exp_f32 v100, v100
    v_cvt_pk_bf16_f32 v41, v98, v99
    v_exp_f32 v101, v101
    v_mfma_f32_32x32x16_bf16 v[112:127], v[28:31], v[44:47], v[112:127]
    v_exp_f32 v102, v102
    v_cvt_pk_bf16_f32 v42, v100, v101
    v_exp_f32 v103, v103
    buffer_load_dwordx4 v[204:207], v2, s[40:43], s64 offen offset:2048 sc1
    v_exp_f32 v104, v104
    v_cvt_pk_bf16_f32 v43, v102, v103
    v_exp_f32 v105, v105
    v_exp_f32 v106, v106
    v_cvt_pk_bf16_f32 v44, v104, v105
    v_mfma_f32_32x32x16_bf16 v[128:143], v[24:27], v[40:43], v[128:143]
    v_exp_f32 v107, v107
    v_exp_f32 v108, v108
    v_cvt_pk_bf16_f32 v45, v106, v107
    buffer_load_dwordx4 v[208:211], v2, s[40:43], s65 offen offset:2048 sc1
    v_exp_f32 v109, v109
    v_exp_f32 v110, v110
    v_exp_f32 v111, v111
    v_cvt_pk_bf16_f32 v46, v108, v109
    v_cvt_pk_bf16_f32 v47, v110, v111
    v_exp_f32 v80, v80
    v_exp_f32 v81, v81
    v_mfma_f32_32x32x16_bf16 v[96:111], v[20:23], v[12:15], v[64:79]
    v_exp_f32 v82, v82
    v_cvt_pk_bf16_f32 v40, v80, v81
    v_exp_f32 v83, v83
    buffer_load_dwordx4 v[212:215], v2, s[40:43], s66 offen sc1
    s_add_u32 s66, s66, 16384
    v_exp_f32 v84, v84
    v_cvt_pk_bf16_f32 v41, v82, v83
    v_exp_f32 v85, v85
    v_mfma_f32_32x32x16_bf16 v[128:143], v[28:31], v[44:47], v[128:143]
    s_mov_b64 exec, s[60:61]
    ds_read_b128 v[24:27], v5 offset:16384
    ds_read_b128 v[28:31], v5 offset:16896
    s_mov_b64 exec, -1
    v_exp_f32 v86, v86
    v_cvt_pk_bf16_f32 v42, v84, v85
    v_exp_f32 v87, v87
    buffer_load_dwordx4 v[216:219], v2, s[40:43], s64 offen offset:3072 sc1
    v_exp_f32 v88, v88
    v_cvt_pk_bf16_f32 v43, v86, v87
    v_exp_f32 v89, v89
    v_exp_f32 v90, v90
    v_cvt_pk_bf16_f32 v44, v88, v89
    v_mfma_f32_32x32x16_bf16 v[112:127], v[32:35], v[40:43], v[112:127]
    v_exp_f32 v91, v91
    v_exp_f32 v92, v92
    v_cvt_pk_bf16_f32 v45, v90, v91
    buffer_load_dwordx4 v[220:223], v2, s[40:43], s65 offen offset:3072 sc1
    s_add_u32 s64, s64, 4096
    s_add_u32 s65, s65, 4096
    v_exp_f32 v93, v93
    v_exp_f32 v94, v94
    v_exp_f32 v95, v95
    v_cvt_pk_bf16_f32 v46, v92, v93
    v_cvt_pk_bf16_f32 v47, v94, v95
    v_exp_f32 v96, v96
    v_exp_f32 v97, v97
    s_waitcnt lgkmcnt(0)
    v_mfma_f32_32x32x16_bf16 v[80:95], v[16:19], v[8:11], v[48:63]
    ds_read_b128 v[20:23], v4 offset:17408
    v_exp_f32 v98, v98
    v_cvt_pk_bf16_f32 v40, v96, v97
    v_exp_f32 v99, v99
    v_exp_f32 v100, v100
    v_cvt_pk_bf16_f32 v41, v98, v99
    v_exp_f32 v101, v101
    v_mfma_f32_32x32x16_bf16 v[112:127], v[36:39], v[44:47], v[112:127]
    v_exp_f32 v102, v102
    v_cvt_pk_bf16_f32 v42, v100, v101
    v_exp_f32 v103, v103
    v_exp_f32 v104, v104
    v_cvt_pk_bf16_f32 v43, v102, v103
    v_exp_f32 v105, v105
    v_exp_f32 v106, v106
    v_cvt_pk_bf16_f32 v44, v104, v105
    v_mfma_f32_32x32x16_bf16 v[128:143], v[32:35], v[40:43], v[128:143]
    v_exp_f32 v107, v107
    v_exp_f32 v108, v108
    v_cvt_pk_bf16_f32 v45, v106, v107
    v_exp_f32 v109, v109
    v_exp_f32 v110, v110
    v_exp_f32 v111, v111
    v_cvt_pk_bf16_f32 v46, v108, v109
    v_cvt_pk_bf16_f32 v47, v110, v111
    v_add_u32 v4, 16384, v4
    v_add_u32 v5, 16384, v5
    s_mov_b32 s63, 5
    s_cmp_lt_u32 s48, 4
    s_cbranch_scc1 A_NOPRI
    s_setprio 1
A_NOPRI:
K2_LOOP:
    v_exp_f32 v80, v80
    v_exp_f32 v81, v81
    v_mfma_f32_32x32x16_bf16 v[96:111], v[16:19], v[12:15], v[64:79]
    v_exp_f32 v82, v82
    v_cvt_pk_bf16_f32 v40, v80, v81
    v_exp_f32 v83, v83
    buffer_load_dwordx4 v[224:227], v2, s[40:43], s66 offen sc1
    s_add_u32 s66, s66, 16384
    s_waitcnt vmcnt(10)
    v_mfma_f32_32x32x16_bf16 v[144:159], v[176:179], v[180:183], v[144:159]
    v_exp_f32 v84, v84
    v_cvt_pk_bf16_f32 v41, v82, v83
    v_exp_f32 v85, v85
    v_mfma_f32_32x32x16_bf16 v[128:143], v[36:39], v[44:47], v[128:143]
    s_mov_b64 exec, s[60:61]
    ds_read_b128 v[32:35], v5 offset:1024
    ds_read_b128 v[36:39], v5 offset:1536
    s_mov_b64 exec, -1
    v_exp_f32 v86, v86
    v_cvt_pk_bf16_f32 v42, v84, v85
    v_exp_f32 v87, v87
    buffer_load_dwordx4 v[228:231], v2, s[40:43], s64 offen offset:0 sc1
    v_exp_f32 v88, v88
    v_cvt_pk_bf16_f32 v43, v86, v87
    v_exp_f32 v89, v89
    v_exp_f32 v90, v90
    v_cvt_pk_bf16_f32 v44, v88, v89
    v_mfma_f32_32x32x16_bf16 v[112:127], v[24:27], v[40:43], v[112:127]
    v_exp_f32 v91, v91
    v_exp_f32 v92, v92
    v_cvt_pk_bf16_f32 v45, v90, v91
    buffer_load_dwordx4 v[232:235], v2, s[40:43], s65 offen offset:0 sc1
    s_add_u32 s64, s64, 1024
    s_add_u32 s65, s65, 1024
    v_exp_f32 v93, v93
    v_mfma_f32_32x32x16_bf16 v[160:175], v[176:179], v[184:187], v[160:175]
    v_exp_f32 v94, v94
    v_exp_f32 v95, v95
    v_cvt_pk_bf16_f32 v46, v92, v93
    v_cvt_pk_bf16_f32 v47, v94, v95
    v_exp_f32 v96, v96
    v_exp_f32 v97, v97
    s_waitcnt lgkmcnt(0)
    v_mfma_f32_32x32x16_bf16 v[80:95], v[20:23], v[8:11], v[48:63]
    ds_read_b128 v[16:19], v4 offset:2048
    v_exp_f32 v98, v98
    v_cvt_pk_bf16_f32 v40, v96, v97
    v_exp_f32 v99, v99
    buffer_load_dwordx4 v[176:179], v2, s[40:43], s66 offen sc1
    s_add_u32 s66, s66, 16384
    v_exp_f32 v100, v100
    v_cvt_pk_bf16_f32 v41, v98, v99
    v_exp_f32 v101, v101
    v_mfma_f32_32x32x16_bf16 v[112:127], v[28:31], v[44:47], v[112:127]
    v_exp_f32 v102, v102
    v_cvt_pk_bf16_f32 v42, v100, v101
    v_exp_f32 v103, v103
    buffer_load_dwordx4 v[180:183], v2, s[40:43], s64 offen offset:0 sc1
    v_exp_f32 v104, v104
    v_cvt_pk_bf16_f32 v43, v102, v103
    v_exp_f32 v105, v105
    v_exp_f32 v106, v106
    v_cvt_pk_bf16_f32 v44, v104, v105
    v_mfma_f32_32x32x16_bf16 v[128:143], v[24:27], v[40:43], v[128:143]
    v_exp_f32 v107, v107
    v_exp_f32 v108, v108
    v_cvt_pk_bf16_f32 v45, v106, v107
    buffer_load_dwordx4 v[184:187], v2, s[40:43], s65 offen offset:0 sc1
    v_exp_f32 v109, v109
    s_waitcnt vmcnt(12)
    v_mfma_f32_32x32x16_bf16 v[144:159], v[188:191], v[192:195], v[144:159]
    v_exp_f32 v110, v110
    v_exp_f32 v111, v111
    v_cvt_pk_bf16_f32 v46, v108, v109
    v_cvt_pk_bf16_f32 v47, v110, v111
    v_exp_f32 v80, v80
    v_exp_f32 v81, v81
    v_mfma_f32_32x32x16_bf16 v[96:111], v[20:23], v[12:15], v[64:79]
    v_exp_f32 v82, v82
    v_cvt_pk_bf16_f32 v40, v80, v81
    v_exp_f32 v83, v83
    v_exp_f32 v84, v84
    v_cvt_pk_bf16_f32 v41, v82, v83
    v_exp_f32 v85, v85
    v_mfma_f32_32x32x16_bf16 v[128:143], v[28:31], v[44:47], v[128:143]
    s_mov_b64 exec, s[60:61]
    ds_read_b128 v[24:27], v5 offset:2048
    ds_read_b128 v[28:31], v5 offset:2560
    s_mov_b64 exec, -1
    v_exp_f32 v86, v86
    v_cvt_pk_bf16_f32 v42, v84, v85
    v_exp_f32 v87, v87
    v_exp_f32 v88, v88
    v_cvt_pk_bf16_f32 v43, v86, v87
    v_exp_f32 v89, v89
    v_exp_f32 v90, v90
    v_cvt_pk_bf16_f32 v44, v88, v89
    v_mfma_f32_32x32x16_bf16 v[112:127], v[32:35], v[40:43], v[112:127]
    v_exp_f32 v91, v91
    v_exp_f32 v92, v92
    v_cvt_pk_bf16_f32 v45, v90, v91
    v_exp_f32 v93, v93
    v_mfma_f32_32x32x16_bf16 v[160:175], v[188:191], v[196:199], v[160:175]
    v_exp_f32 v94, v94
    v_exp_f32 v95, v95
    v_cvt_pk_bf16_f32 v46, v92, v93
    v_cvt_pk_bf16_f32 v47, v94, v95
    v_exp_f32 v96, v96
    v_exp_f32 v97, v97
    s_waitcnt lgkmcnt(0)
    v_mfma_f32_32x32x16_bf16 v[80:95], v[16:19], v[8:11], v[48:63]
    ds_read_b128 v[20:23], v4 offset:3072
    v_exp_f32 v98, v98
    v_cvt_pk_bf16_f32 v40, v96, v97
    v_exp_f32 v99, v99
    buffer_load_dwordx4 v[188:191], v2, s[40:43], s66 offen sc1
    s_add_u32 s66, s66, 16384
    v_exp_f32 v100, v100
    v_cvt_pk_bf16_f32 v41, v98, v99
    v_exp_f32 v101, v101
    v_mfma_f32_32x32x16_bf16 v[112:127], v[36:39], v[44:47], v[112:127]
    v_exp_f32 v102, v102
    v_cvt_pk_bf16_f32 v42, v100, v101
    v_exp_f32 v103, v103
    buffer_load_dwordx4 v[192:195], v2, s[40:43], s64 offen offset:1024 sc1
    v_exp_f32 v104, v104
    v_cvt_pk_bf16_f32 v43, v102, v103
    v_exp_f32 v105, v105
    v_exp_f32 v106, v106
    v_cvt_pk_bf16_f32 v44, v104, v105
    v_mfma_f32_32x32x16_bf16 v[128:143], v[32:35], v[40:43], v[128:143]
    v_exp_f32 v107, v107
    v_exp_f32 v108, v108
    v_cvt_pk_bf16_f32 v45, v106, v107
    buffer_load_dwordx4 v[196:199], v2, s[40:43], s65 offen offset:1024 sc1
    v_exp_f32 v109, v109
    s_waitcnt vmcnt(12)
    v_mfma_f32_32x32x16_bf16 v[144:159], v[200:203], v[204:207], v[144:159]
    v_exp_f32 v110, v110
    v_exp_f32 v111, v111
    v_cvt_pk_bf16_f32 v46, v108, v109
    v_cvt_pk_bf16_f32 v47, v110, v111
    v_exp_f32 v80, v80
    v_exp_f32 v81, v81
    v_mfma_f32_32x32x16_bf16 v[96:111], v[16:19], v[12:15], v[64:79]
    v_exp_f32 v82, v82
    v_cvt_pk_bf16_f32 v40, v80, v81
    v_exp_f32 v83, v83
    v_mfma_f32_32x32x16_bf16 v[160:175], v[200:203], v[208:211], v[160:175]
    v_exp_f32 v84, v84
    v_cvt_pk_bf16_f32 v41, v82, v83
    v_exp_f32 v85, v85
    v_mfma_f32_32x32x16_bf16 v[128:143], v[36:39], v[44:47], v[128:143]
    s_mov_b64 exec, s[60:61]
    ds_read_b128 v[32:35], v5 offset:3072
    ds_read_b128 v[36:39], v5 offset:3584
    s_mov_b64 exec, -1
    v_exp_f32 v86, v86
    v_cvt_pk_bf16_f32 v42, v84, v85
    v_exp_f32 v87, v87
    v_exp_f32 v88, v88
    v_cvt_pk_bf16_f32 v43, v86, v87
    v_exp_f32 v89, v89
    v_exp_f32 v90, v90
    v_cvt_pk_bf16_f32 v44, v88, v89
    v_mfma_f32_32x32x16_bf16 v[112:127], v[24:27], v[40:43], v[112:127]
    v_exp_f32 v91, v91
    v_exp_f32 v92, v92
    v_cvt_pk_bf16_f32 v45, v90, v91
    v_exp_f32 v93, v93
    s_waitcnt vmcnt(9)
    v_mfma_f32_32x32x16_bf16 v[144:159], v[212:215], v[216:219], v[144:159]
    v_exp_f32 v94, v94
    v_exp_f32 v95, v95
    v_cvt_pk_bf16_f32 v46, v92, v93
    v_cvt_pk_bf16_f32 v47, v94, v95
    v_exp_f32 v96, v96
    v_exp_f32 v97, v97
    s_waitcnt lgkmcnt(0)
    v_mfma_f32_32x32x16_bf16 v[80:95], v[20:23], v[8:11], v[48:63]
    ds_read_b128 v[16:19], v4 offset:16384
    v_exp_f32 v98, v98
    v_cvt_pk_bf16_f32 v40, v96, v97
    v_exp_f32 v99, v99
    buffer_load_dwordx4 v[200:203], v2, s[40:43], s66 offen sc1
    s_add_u32 s66, s66, 16384
    v_exp_f32 v100, v100
    v_cvt_pk_bf16_f32 v41, v98, v99
    v_exp_f32 v101, v101
    v_mfma_f32_32x32x16_bf16 v[112:127], v[28:31], v[44:47], v[112:127]
    v_exp_f32 v102, v102
    v_cvt_pk_bf16_f32 v42, v100, v101
    v_exp_f32 v103, v103
    buffer_load_dwordx4 v[204:207], v2, s[40:43], s64 offen offset:2048 sc1
    v_exp_f32 v104, v104
    v_cvt_pk_bf16_f32 v43, v102, v103
    v_exp_f32 v105, v105
    v_exp_f32 v106, v106
    v_cvt_pk_bf16_f32 v44, v104, v105
    v_mfma_f32_32x32x16_bf16 v[128:143], v[24:27], v[40:43], v[128:143]
    v_exp_f32 v107, v107
    v_exp_f32 v108, v108
    v_cvt_pk_bf16_f32 v45, v106, v107
    buffer_load_dwordx4 v[208:211], v2, s[40:43], s65 offen offset:2048 sc1
    v_exp_f32 v109, v109
    v_mfma_f32_32x32x16_bf16 v[160:175], v[212:215], v[220:223], v[160:175]
    v_exp_f32 v110, v110
    v_exp_f32 v111, v111
    v_cvt_pk_bf16_f32 v46, v108, v109
    v_cvt_pk_bf16_f32 v47, v110, v111
    v_exp_f32 v80, v80
    v_exp_f32 v81, v81
    v_mfma_f32_32x32x16_bf16 v[96:111], v[20:23], v[12:15], v[64:79]
    v_exp_f32 v82, v82
    v_cvt_pk_bf16_f32 v40, v80, v81
    v_exp_f32 v83, v83
    buffer_load_dwordx4 v[212:215], v2, s[40:43], s66 offen sc1
    s_add_u32 s66, s66, 16384
    v_exp_f32 v84, v84
    v_cvt_pk_bf16_f32 v41, v82, v83
    v_exp_f32 v85, v85
    v_mfma_f32_32x32x16_bf16 v[128:143], v[28:31], v[44:47], v[128:143]
    s_mov_b64 exec, s[60:61]
    ds_read_b128 v[24:27], v5 offset:16384
    ds_read_b128 v[28:31], v5 offset:16896
    s_mov_b64 exec, -1
    v_exp_f32 v86, v86
    v_cvt_pk_bf16_f32 v42, v84, v85
    v_exp_f32 v87, v87
    buffer_load_dwordx4 v[216:219], v2, s[40:43], s64 offen offset:3072 sc1
    v_exp_f32 v88, v88
    v_cvt_pk_bf16_f32 v43, v86, v87
    v_exp_f32 v89, v89
    v_exp_f32 v90, v90
    v_cvt_pk_bf16_f32 v44, v88, v89
    v_mfma_f32_32x32x16_bf16 v[112:127], v[32:35], v[40:43], v[112:127]
    v_exp_f32 v91, v91
    v_exp_f32 v92, v92
    v_cvt_pk_bf16_f32 v45, v90, v91
    buffer_load_dwordx4 v[220:223], v2, s[40:43], s65 offen offset:3072 sc1
    s_add_u32 s64, s64, 4096
    s_add_u32 s65, s65, 4096
    v_exp_f32 v93, v93
    s_waitcnt vmcnt(12)
    v_mfma_f32_32x32x16_bf16 v[144:159], v[224:227], v[228:231], v[144:159]
    v_exp_f32 v94, v94
    v_exp_f32 v95, v95
    v_cvt_pk_bf16_f32 v46, v92, v93
    v_cvt_pk_bf16_f32 v47, v94, v95
    v_exp_f32 v96, v96
    v_exp_f32 v97, v97
    s_waitcnt lgkmcnt(0)
    v_mfma_f32_32x32x16_bf16 v[80:95], v[16:19], v[8:11], v[48:63]
    ds_read_b128 v[20:23], v4 offset:17408
    v_exp_f32 v98, v98
    v_cvt_pk_bf16_f32 v40, v96, v97
    v_exp_f32 v99, v99
    v_exp_f32 v100, v100
    v_cvt_pk_bf16_f32 v41, v98, v99
    v_exp_f32 v101, v101
    v_mfma_f32_32x32x16_bf16 v[112:127], v[36:39], v[44:47], v[112:127]
    v_exp_f32 v102, v102
    v_cvt_pk_bf16_f32 v42, v100, v101
    v_exp_f32 v103, v103
    v_exp_f32 v104, v104
    v_cvt_pk_bf16_f32 v43, v102, v103
    v_exp_f32 v105, v105
    v_exp_f32 v106, v106
    v_cvt_pk_bf16_f32 v44, v104, v105
    v_mfma_f32_32x32x16_bf16 v[128:143], v[32:35], v[40:43], v[128:143]
    v_exp_f32 v107, v107
    v_exp_f32 v108, v108
    v_cvt_pk_bf16_f32 v45, v106, v107
    v_exp_f32 v109, v109
    v_mfma_f32_32x32x16_bf16 v[160:175], v[224:227], v[232:235], v[160:175]
    v_exp_f32 v110, v110
    v_exp_f32 v111, v111
    v_cvt_pk_bf16_f32 v46, v108, v109
    v_cvt_pk_bf16_f32 v47, v110, v111
    v_add_u32 v4, 16384, v4
    v_add_u32 v5, 16384, v5
    s_sub_u32 s63, s63, 1
    s_cmp_lg_u32 s63, 1
    s_cbranch_scc1 A_KEEPPRI
    s_setprio 0
A_KEEPPRI:
    s_cmp_lg_u32 s63, 0
    s_cbranch_scc1 K2_LOOP
    s_lshl_b32 s64, s53, 8
    s_lshl_b32 s65, s50, 1
    s_add_u32 s64, s64, s65
    s_and_b32 s65, s48, 1
    s_add_u32 s64, s64, s65
    s_lshl_b32 s64, s64, 10
    s_add_u32 s64, s64, 18874368
    v_exp_f32 v80, v80
    v_exp_f32 v81, v81
    v_mfma_f32_32x32x16_bf16 v[96:111], v[16:19], v[12:15], v[64:79]
    v_exp_f32 v82, v82
    v_cvt_pk_bf16_f32 v40, v80, v81
    v_exp_f32 v83, v83
    s_add_u32 s65, s64, 147456
    buffer_load_dwordx4 v[212:215], v2, s[40:43], s65 offen sc1
    v_exp_f32 v84, v84
    v_cvt_pk_bf16_f32 v41, v82, v83
    v_exp_f32 v85, v85
    v_mfma_f32_32x32x16_bf16 v[128:143], v[36:39], v[44:47], v[128:143]
    s_mov_b64 exec, s[60:61]
    ds_read_b128 v[32:35], v5 offset:1024
    ds_read_b128 v[36:39], v5 offset:1536
    s_mov_b64 exec, -1
    v_exp_f32 v86, v86
    v_cvt_pk_bf16_f32 v42, v84, v85
    v_exp_f32 v87, v87
    s_add_u32 s65, s64, 163840
    buffer_load_dwordx4 v[216:219], v2, s[40:43], s65 offen sc1
    v_exp_f32 v88, v88
    v_cvt_pk_bf16_f32 v43, v86, v87
    v_exp_f32 v89, v89
    v_exp_f32 v90, v90
    v_cvt_pk_bf16_f32 v44, v88, v89
    v_mfma_f32_32x32x16_bf16 v[112:127], v[24:27], v[40:43], v[112:127]
    v_exp_f32 v91, v91
    v_exp_f32 v92, v92
    v_cvt_pk_bf16_f32 v45, v90, v91
    s_add_u32 s65, s64, 180224
    buffer_load_dwordx4 v[220:223], v2, s[40:43], s65 offen sc1
    v_exp_f32 v93, v93
    s_waitcnt vmcnt(12)
    v_mfma_f32_32x32x16_bf16 v[144:159], v[176:179], v[180:183], v[144:159]
    v_exp_f32 v94, v94
    v_exp_f32 v95, v95
    v_cvt_pk_bf16_f32 v46, v92, v93
    v_cvt_pk_bf16_f32 v47, v94, v95
    v_exp_f32 v96, v96
    v_exp_f32 v97, v97
    s_waitcnt lgkmcnt(0)
    v_mfma_f32_32x32x16_bf16 v[80:95], v[20:23], v[8:11], v[48:63]
    ds_read_b128 v[16:19], v4 offset:2048
    v_exp_f32 v98, v98
    v_cvt_pk_bf16_f32 v40, v96, v97
    v_exp_f32 v99, v99
    s_add_u32 s65, s64, 196608
    buffer_load_dwordx4 v[224:227], v2, s[40:43], s65 offen sc1
    v_exp_f32 v100, v100
    v_cvt_pk_bf16_f32 v41, v98, v99
    v_exp_f32 v101, v101
    v_mfma_f32_32x32x16_bf16 v[112:127], v[28:31], v[44:47], v[112:127]
    v_exp_f32 v102, v102
    v_cvt_pk_bf16_f32 v42, v100, v101
    v_exp_f32 v103, v103
    s_add_u32 s65, s64, 212992
    buffer_load_dwordx4 v[228:231], v2, s[40:43], s65 offen sc1
    v_exp_f32 v104, v104
    v_cvt_pk_bf16_f32 v43, v102, v103
    v_exp_f32 v105, v105
    v_exp_f32 v106, v106
    v_cvt_pk_bf16_f32 v44, v104, v105
    v_mfma_f32_32x32x16_bf16 v[128:143], v[24:27], v[40:43], v[128:143]
    v_exp_f32 v107, v107
    v_exp_f32 v108, v108
    v_cvt_pk_bf16_f32 v45, v106, v107
    s_add_u32 s65, s64, 229376
    buffer_load_dwordx4 v[232:235], v2, s[40:43], s65 offen sc1
    v_exp_f32 v109, v109
    v_mfma_f32_32x32x16_bf16 v[160:175], v[176:179], v[184:187], v[160:175]
    v_exp_f32 v110, v110
    v_exp_f32 v111, v111
    v_cvt_pk_bf16_f32 v46, v108, v109
    v_cvt_pk_bf16_f32 v47, v110, v111
    v_exp_f32 v80, v80
    v_exp_f32 v81, v81
    v_mfma_f32_32x32x16_bf16 v[96:111], v[20:23], v[12:15], v[64:79]
    v_exp_f32 v82, v82
    v_cvt_pk_bf16_f32 v40, v80, v81
    v_exp_f32 v83, v83
    s_add_u32 s65, s64, 245760
    buffer_load_dwordx4 v[236:239], v2, s[40:43], s65 offen sc1
    v_exp_f32 v84, v84
    v_cvt_pk_bf16_f32 v41, v82, v83
    v_exp_f32 v85, v85
    v_mfma_f32_32x32x16_bf16 v[128:143], v[28:31], v[44:47], v[128:143]
    s_mov_b64 exec, s[60:61]
    ds_read_b128 v[24:27], v5 offset:2048
    ds_read_b128 v[28:31], v5 offset:2560
    s_mov_b64 exec, -1
    v_exp_f32 v86, v86
    v_cvt_pk_bf16_f32 v42, v84, v85
    v_exp_f32 v87, v87
    s_add_u32 s65, s64, 0
    buffer_load_dwordx4 v[176:179], v2, s[40:43], s65 offen sc1
    v_exp_f32 v88, v88
    v_cvt_pk_bf16_f32 v43, v86, v87
    v_exp_f32 v89, v89
    v_exp_f32 v90, v90
    v_cvt_pk_bf16_f32 v44, v88, v89
    v_mfma_f32_32x32x16_bf16 v[112:127], v[32:35], v[40:43], v[112:127]
    v_exp_f32 v91, v91
    v_exp_f32 v92, v92
    v_cvt_pk_bf16_f32 v45, v90, v91
    s_add_u32 s65, s64, 16384
    buffer_load_dwordx4 v[180:183], v2, s[40:43], s65 offen sc1
    v_exp_f32 v93, v93
    s_waitcnt vmcnt(15)
    v_mfma_f32_32x32x16_bf16 v[144:159], v[188:191], v[192:195], v[144:159]
    v_exp_f32 v94, v94
    v_exp_f32 v95, v95
    v_cvt_pk_bf16_f32 v46, v92, v93
    v_cvt_pk_bf16_f32 v47, v94, v95
    v_exp_f32 v96, v96
    v_exp_f32 v97, v97
    s_waitcnt lgkmcnt(0)
    v_mfma_f32_32x32x16_bf16 v[80:95], v[16:19], v[8:11], v[48:63]
    ds_read_b128 v[20:23], v4 offset:3072
    v_exp_f32 v98, v98
    v_cvt_pk_bf16_f32 v40, v96, v97
    v_exp_f32 v99, v99
    s_add_u32 s65, s64, 32768
    buffer_load_dwordx4 v[184:187], v2, s[40:43], s65 offen sc1
    v_exp_f32 v100, v100
    v_cvt_pk_bf16_f32 v41, v98, v99
    v_exp_f32 v101, v101
    v_mfma_f32_32x32x16_bf16 v[112:127], v[36:39], v[44:47], v[112:127]
    v_exp_f32 v102, v102
    v_cvt_pk_bf16_f32 v42, v100, v101
    v_exp_f32 v103, v103
    v_exp_f32 v104, v104
    v_cvt_pk_bf16_f32 v43, v102, v103
    v_exp_f32 v105, v105
    v_exp_f32 v106, v106
    v_cvt_pk_bf16_f32 v44, v104, v105
    v_mfma_f32_32x32x16_bf16 v[128:143], v[32:35], v[40:43], v[128:143]
    v_exp_f32 v107, v107
    v_exp_f32 v108, v108
    v_cvt_pk_bf16_f32 v45, v106, v107
    v_exp_f32 v109, v109
    v_mfma_f32_32x32x16_bf16 v[160:175], v[188:191], v[196:199], v[160:175]
    v_exp_f32 v110, v110
    v_exp_f32 v111, v111
    v_cvt_pk_bf16_f32 v46, v108, v109
    v_cvt_pk_bf16_f32 v47, v110, v111
    v_exp_f32 v80, v80
    v_exp_f32 v81, v81
    v_mfma_f32_32x32x16_bf16 v[96:111], v[16:19], v[12:15], v[64:79]
    v_exp_f32 v82, v82
    v_cvt_pk_bf16_f32 v40, v80, v81
    v_exp_f32 v83, v83
    s_add_u32 s65, s64, 49152
    buffer_load_dwordx4 v[188:191], v2, s[40:43], s65 offen sc1
    v_exp_f32 v84, v84
    v_cvt_pk_bf16_f32 v41, v82, v83
    v_exp_f32 v85, v85
    v_mfma_f32_32x32x16_bf16 v[128:143], v[36:39], v[44:47], v[128:143]
    s_mov_b64 exec, s[60:61]
    ds_read_b128 v[32:35], v5 offset:3072
    ds_read_b128 v[36:39], v5 offset:3584
    s_mov_b64 exec, -1
    v_exp_f32 v86, v86
    v_cvt_pk_bf16_f32 v42, v84, v85
    v_exp_f32 v87, v87
    s_add_u32 s65, s64, 65536
    buffer_load_dwordx4 v[192:195], v2, s[40:43], s65 offen sc1
    v_exp_f32 v88, v88
    v_cvt_pk_bf16_f32 v43, v86, v87
    v_exp_f32 v89, v89
    v_exp_f32 v90, v90
    v_cvt_pk_bf16_f32 v44, v88, v89
    v_mfma_f32_32x32x16_bf16 v[112:127], v[24:27], v[40:43], v[112:127]
    v_exp_f32 v91, v91
    v_exp_f32 v92, v92
    v_cvt_pk_bf16_f32 v45, v90, v91
    s_add_u32 s65, s64, 81920
    buffer_load_dwordx4 v[196:199], v2, s[40:43], s65 offen sc1
    v_exp_f32 v93, v93
    s_waitcnt vmcnt(16)
    v_mfma_f32_32x32x16_bf16 v[144:159], v[200:203], v[204:207], v[144:159]
    v_exp_f32 v94, v94
    v_exp_f32 v95, v95
    v_cvt_pk_bf16_f32 v46, v92, v93
    v_cvt_pk_bf16_f32 v47, v94, v95
    v_exp_f32 v96, v96
    v_exp_f32 v97, v97
    s_waitcnt lgkmcnt(0)
    v_mfma_f32_32x32x16_bf16 v[80:95], v[20:23], v[8:11], v[48:63]
    v_exp_f32 v98, v98
    v_cvt_pk_bf16_f32 v40, v96, v97
    v_exp_f32 v99, v99
    v_exp_f32 v100, v100
    v_cvt_pk_bf16_f32 v41, v98, v99
    v_exp_f32 v101, v101
    v_mfma_f32_32x32x16_bf16 v[112:127], v[28:31], v[44:47], v[112:127]
    v_exp_f32 v102, v102
    v_cvt_pk_bf16_f32 v42, v100, v101
    v_exp_f32 v103, v103
    v_exp_f32 v104, v104
    v_cvt_pk_bf16_f32 v43, v102, v103
    v_exp_f32 v105, v105
    v_exp_f32 v106, v106
    v_cvt_pk_bf16_f32 v44, v104, v105
    v_mfma_f32_32x32x16_bf16 v[128:143], v[24:27], v[40:43], v[128:143]
    v_exp_f32 v107, v107
    v_exp_f32 v108, v108
    v_cvt_pk_bf16_f32 v45, v106, v107
    v_exp_f32 v109, v109
    v_mfma_f32_32x32x16_bf16 v[160:175], v[200:203], v[208:211], v[160:175]
    v_exp_f32 v110, v110
    v_exp_f32 v111, v111
    v_cvt_pk_bf16_f32 v46, v108, v109
    v_cvt_pk_bf16_f32 v47, v110, v111
    v_exp_f32 v80, v80
    v_exp_f32 v81, v81
    v_mfma_f32_32x32x16_bf16 v[96:111], v[20:23], v[12:15], v[64:79]
    v_exp_f32 v82, v82
    v_cvt_pk_bf16_f32 v40, v80, v81
    v_exp_f32 v83, v83
    s_add_u32 s65, s64, 98304
    buffer_load_dwordx4 v[200:203], v2, s[40:43], s65 offen sc1
    v_exp_f32 v84, v84
    v_cvt_pk_bf16_f32 v41, v82, v83
    v_exp_f32 v85, v85
    v_mfma_f32_32x32x16_bf16 v[128:143], v[28:31], v[44:47], v[128:143]
    v_exp_f32 v86, v86
    v_cvt_pk_bf16_f32 v42, v84, v85
    v_exp_f32 v87, v87
    s_add_u32 s65, s64, 114688
    buffer_load_dwordx4 v[204:207], v2, s[40:43], s65 offen sc1
    v_exp_f32 v88, v88
    v_cvt_pk_bf16_f32 v43, v86, v87
    v_exp_f32 v89, v89
    v_exp_f32 v90, v90
    v_cvt_pk_bf16_f32 v44, v88, v89
    v_mfma_f32_32x32x16_bf16 v[112:127], v[32:35], v[40:43], v[112:127]
    v_exp_f32 v91, v91
    v_exp_f32 v92, v92
    v_cvt_pk_bf16_f32 v45, v90, v91
    s_add_u32 s65, s64, 131072
    buffer_load_dwordx4 v[208:211], v2, s[40:43], s65 offen sc1
    v_exp_f32 v93, v93
    v_exp_f32 v94, v94
    v_exp_f32 v95, v95
    v_cvt_pk_bf16_f32 v46, v92, v93
    v_cvt_pk_bf16_f32 v47, v94, v95
    v_exp_f32 v96, v96
    v_exp_f32 v97, v97
    s_waitcnt lgkmcnt(0)
    v_exp_f32 v98, v98
    v_cvt_pk_bf16_f32 v40, v96, v97
    v_exp_f32 v99, v99
    v_exp_f32 v100, v100
    v_cvt_pk_bf16_f32 v41, v98, v99
    v_exp_f32 v101, v101
    v_mfma_f32_32x32x16_bf16 v[112:127], v[36:39], v[44:47], v[112:127]
    v_exp_f32 v102, v102
    v_cvt_pk_bf16_f32 v42, v100, v101
    v_exp_f32 v103, v103
    v_exp_f32 v104, v104
    v_cvt_pk_bf16_f32 v43, v102, v103
    v_exp_f32 v105, v105
    v_exp_f32 v106, v106
    v_cvt_pk_bf16_f32 v44, v104, v105
    v_mfma_f32_32x32x16_bf16 v[128:143], v[32:35], v[40:43], v[128:143]
    v_exp_f32 v107, v107
    v_exp_f32 v108, v108
    v_cvt_pk_bf16_f32 v45, v106, v107
    v_exp_f32 v109, v109
    v_exp_f32 v110, v110
    v_exp_f32 v111, v111
    v_cvt_pk_bf16_f32 v46, v108, v109
    v_cvt_pk_bf16_f32 v47, v110, v111
    s_bfe_u32 s62, s48, 0x10001
    s_lshl_b32 s63, s49, 1
    v_mfma_f32_32x32x16_bf16 v[128:143], v[36:39], v[44:47], v[128:143]
    s_add_u32 s63, s63, s62
    v_and_b32 v249, 31, v1
    v_lshlrev_b32 v249, 2, v249
    s_lshl_b32 s64, s63, 7
    s_add_u32 s64, s64, 19922944
    buffer_load_dword v248, v249, s[40:43], s64 offen sc1
    s_lshl_b32 s62, s48, 12
    s_add_u32 s62, s62, 131072
    v_add_u32 v240, s62, v2
    s_xor_b32 s62, s62, 0x4000
    v_add_u32 v241, s62, v2
    s_cmp_eq_u32 s53, 0
    s_cbranch_scc1 K2_KEEPA
    ds_write_b128 v240, v[112:115]
    ds_write_b128 v240, v[116:119] offset:1024
    ds_write_b32 v240, v120 offset:2048
    s_nop 4
    v_mov_b32 v112, v128
    v_mov_b32 v113, v129
    v_mov_b32 v114, v130
    v_mov_b32 v115, v131
    v_mov_b32 v116, v132
    v_mov_b32 v117, v133
    v_mov_b32 v118, v134
    v_mov_b32 v119, v135
    v_mov_b32 v120, v136
    v_mov_b32 v8, v12
    v_mov_b32 v9, v13
    v_mov_b32 v10, v14
    v_mov_b32 v11, v15
    s_branch K2_SENT
K2_KEEPA:
    s_nop 3
    ds_write_b128 v240, v[128:131]
    ds_write_b128 v240, v[132:135] offset:1024
    ds_write_b32 v240, v136 offset:2048
K2_SENT:
    s_waitcnt lgkmcnt(0)
    s_barrier
    ds_read_b128 v[80:83], v241
    ds_read_b128 v[84:87], v241 offset:1024
    ds_read_b32 v88, v241 offset:2048
    s_waitcnt lgkmcnt(0)
    v_add_f32 v112, v112, v80
    v_add_f32 v113, v113, v81
    v_add_f32 v114, v114, v82
    v_add_f32 v115, v115, v83
    v_add_f32 v116, v116, v84
    v_add_f32 v117, v117, v85
    v_add_f32 v118, v118, v86
    v_add_f32 v119, v119, v87
    v_add_f32 v120, v120, v88
    v_max3_f32 v242, |v112|, |v113|, |v114|
    v_max3_f32 v242, v242, |v115|, |v116|
    v_max3_f32 v242, v242, |v117|, |v118|
    v_add_f32 v243, v112, v113
    v_add_f32 v243, v243, v114
    v_add_f32 v243, v243, v115
    v_add_f32 v243, v243, v116
    v_add_f32 v243, v243, v117
    v_add_f32 v243, v243, v118
    v_add_f32 v243, v243, v119
    v_add_f32 v243, v243, v120
    v_max3_f32 v242, v242, |v119|, v120
    v_mul_f32 v243, 0, v243
    v_add_f32 v242, v242, v243
    v_mov_b32 v244, 0x71800000
    v_cmp_nlt_f32 vcc, v242, v244
    s_cmp_lg_u64 vcc, 0
    s_cbranch_scc1 K2_SLOW
K2_FIN:
    v_rcp_f32 v242, v120
    s_nop 0
    v_mul_f32 v112, v242, v112
    v_mul_f32 v113, v242, v113
    v_mul_f32 v114, v242, v114
    v_mul_f32 v115, v242, v115
    v_mul_f32 v116, v242, v116
    v_mul_f32 v117, v242, v117
    v_mul_f32 v118, v242, v118
    v_mul_f32 v119, v242, v119
    v_cvt_pk_bf16_f32 v40, v112, v113
    v_cvt_pk_bf16_f32 v41, v114, v115
    v_cvt_pk_bf16_f32 v42, v116, v117
    v_cvt_pk_bf16_f32 v43, v118, v119
    s_add_u32 s62, s55, s53
    s_lshl_b32 s62, s62, 5
    s_add_u32 s62, s62, s51
    s_lshl_b32 s62, s62, 10
    s_add_u32 s62, s62, 6291456
    buffer_store_dwordx4 v[40:43], v2, s[40:43], s62 offen sc1
    s_bfe_u32 s62, s48, 0x10001
    s_barrier
    s_lshl_b32 s66, s48, 13
    v_add_u32 v240, s66, v2
    ds_write_b128 v240, v[144:147] offset:0
    ds_write_b128 v240, v[148:151] offset:1024
    ds_write_b128 v240, v[152:155] offset:2048
    ds_write_b128 v240, v[156:159] offset:3072
    ds_write_b128 v240, v[160:163] offset:4096
    ds_write_b128 v240, v[164:167] offset:5120
    ds_write_b128 v240, v[168:171] offset:6144
    ds_write_b128 v240, v[172:175] offset:7168
    s_and_b32 s66, s48, 1
    s_lshl_b32 s66, s66, 13
    s_lshl_b32 s65, s62, 12
    s_add_u32 s66, s66, s65
    s_lshl_b32 s65, s53, 11
    s_add_u32 s66, s66, s65
    v_add_u32 v241, s66, v2
    s_waitcnt vmcnt(0) lgkmcnt(0)
    s_barrier
    v_lshlrev_b32 v242, 2, v1
    s_cmp_lg_u32 s48, 0
    s_cbranch_scc1 A_FL4
    s_add_u32 s37, s39, 4
    v_mov_b32 v0, s37
    s_mov_b32 exec_hi, 0
    buffer_store_dword v0, v242, s[40:43], s36 offen sc1
    s_mov_b32 exec_hi, -1
A_FL4:
    s_mov_b32 s24, s4
    s_mov_b32 s25, s5
    s_mov_b32 s26, 0x200000
    s_mov_b32 s27, 0x00020000
    s_mov_b32 s28, s18
    s_mov_b32 s29, s19
    s_mov_b32 s30, 0x200000
    s_mov_b32 s31, 0x00020000
    v_and_b32 v243, 31, v1
    v_lshlrev_b32 v243, 10, v243
    v_lshrrev_b32 v242, 5, v1
    v_lshl_add_u32 v243, v242, 3, v243
    s_lshl_b32 s67, s63, 15
    s_lshl_b32 s65, s50, 7
    s_add_u32 s67, s67, s65
    s_and_b32 s65, s48, 1
    s_lshl_b32 s65, s65, 6
    s_add_u32 s67, s67, s65
    s_lshl_b32 s65, s53, 5
    s_add_u32 s67, s67, s65
    buffer_load_dwordx2 v[72:73], v243, s[24:27], s67 offen
    buffer_load_dwordx2 v[74:75], v243, s[24:27], s67 offen offset:16
    s_lshr_b32 s65, s49, 2
    s_lshl_b32 s65, s65, 3
    v_bfe_u32 v6, v1, 3, 2
    v_lshlrev_b32 v6, 6, v6
    v_and_b32 v7, 7, v1
    v_add3_u32 v7, v6, v7, s65
    v_lshlrev_b32 v7, 7, v7
    v_add_u32 v7, 23068672, v7
    ds_read_b128 v[80:83], v241 offset:0
    ds_read_b128 v[84:87], v241 offset:1024
    ds_read_b128 v[88:91], v241 offset:16384
    ds_read_b128 v[92:95], v241 offset:17408
    ds_read_b128 v[96:99], v241 offset:32768
    ds_read_b128 v[100:103], v241 offset:33792
    ds_read_b128 v[104:107], v241 offset:49152
    ds_read_b128 v[108:111], v241 offset:50176
    s_waitcnt lgkmcnt(4)
    v_add_f32 v80, v80, v88
    v_add_f32 v81, v81, v89
    v_add_f32 v82, v82, v90
    v_add_f32 v83, v83, v91
    v_add_f32 v84, v84, v92
    v_add_f32 v85, v85, v93
    v_add_f32 v86, v86, v94
    v_add_f32 v87, v87, v95
    s_waitcnt lgkmcnt(0)
    v_add_f32 v96, v96, v104
    v_add_f32 v97, v97, v105
    v_add_f32 v98, v98, v106
    v_add_f32 v99, v99, v107
    v_add_f32 v100, v100, v108
    v_add_f32 v101, v101, v109
    v_add_f32 v102, v102, v110
    v_add_f32 v103, v103, v111
    v_add_f32 v80, v80, v96
    v_add_f32 v81, v81, v97
    v_add_f32 v82, v82, v98
    v_add_f32 v83, v83, v99
    v_add_f32 v84, v84, v100
    v_add_f32 v85, v85, v101
    v_add_f32 v86, v86, v102
    v_add_f32 v87, v87, v103
    v_mul_f32 v80, v248, v80
    v_mul_f32 v81, v248, v81
    v_mul_f32 v82, v248, v82
    v_mul_f32 v83, v248, v83
    v_mul_f32 v84, v248, v84
    v_mul_f32 v85, v248, v85
    v_mul_f32 v86, v248, v86
    v_mul_f32 v87, v248, v87
    v_mul_f32 v88, 0xbfb8aa3b, v80
    v_exp_f32 v88, v88
    v_mul_f32 v89, 0xbfb8aa3b, v81
    v_exp_f32 v89, v89
    v_mul_f32 v90, 0xbfb8aa3b, v82
    v_exp_f32 v90, v90
    v_mul_f32 v91, 0xbfb8aa3b, v83
    v_exp_f32 v91, v91
    v_mul_f32 v92, 0xbfb8aa3b, v84
    v_exp_f32 v92, v92
    v_mul_f32 v93, 0xbfb8aa3b, v85
    v_exp_f32 v93, v93
    v_mul_f32 v94, 0xbfb8aa3b, v86
    v_exp_f32 v94, v94
    v_mul_f32 v95, 0xbfb8aa3b, v87
    v_exp_f32 v95, v95
    v_add_f32 v88, 1.0, v88
    v_rcp_f32 v88, v88
    v_add_f32 v89, 1.0, v89
    v_rcp_f32 v89, v89
    v_add_f32 v90, 1.0, v90
    v_rcp_f32 v90, v90
    v_add_f32 v91, 1.0, v91
    v_rcp_f32 v91, v91
    v_add_f32 v92, 1.0, v92
    v_rcp_f32 v92, v92
    v_add_f32 v93, 1.0, v93
    v_rcp_f32 v93, v93
    v_add_f32 v94, 1.0, v94
    v_rcp_f32 v94, v94
    v_add_f32 v95, 1.0, v95
    v_rcp_f32 v95, v95
    v_mul_f32 v80, v80, v88
    v_mul_f32 v81, v81, v89
    v_mul_f32 v82, v82, v90
    v_mul_f32 v83, v83, v91
    v_mul_f32 v84, v84, v92
    v_mul_f32 v85, v85, v93
    v_mul_f32 v86, v86, v94
    v_mul_f32 v87, v87, v95
    v_cvt_pk_bf16_f32 v96, v80, v81
    v_cvt_pk_bf16_f32 v97, v82, v83
    v_cvt_pk_bf16_f32 v98, v84, v85
    v_cvt_pk_bf16_f32 v99, v86, v87
    v_lshlrev_b32 v80, 16, v96
    v_and_b32 v81, 0xffff0000, v96
    v_lshlrev_b32 v82, 16, v97
    v_and_b32 v83, 0xffff0000, v97
    v_lshlrev_b32 v84, 16, v98
    v_and_b32 v85, 0xffff0000, v98
    v_lshlrev_b32 v86, 16, v99
    v_and_b32 v87, 0xffff0000, v99
    s_lshl_b32 s64, s63, 15
    s_lshl_b32 s65, s53, 14
    s_add_u32 s64, s64, s65
    s_add_u32 s64, s64, 6291456
    s_cmp_lg_u32 s48, 0
    s_cbranch_scc1 A_P4_OK
    buffer_load_dword v6, v7, s[40:43], 0 offen sc1
    s_waitcnt vmcnt(0)
    s_mov_b32 s37, 262144
    s_add_u32 s38, s39, 4
A_P4_CHK:
    v_subrev_u32 v6, s38, v6
    v_cmp_lt_u32 vcc, 3, v6
    s_cmp_eq_u64 vcc, 0
    s_cbranch_scc1 A_P4_OK
    s_sub_u32 s37, s37, 1
    s_cmp_eq_u32 s37, 0
    s_cbranch_scc1 A_P4_OK
    s_sleep 1
    buffer_load_dword v6, v7, s[40:43], 0 offen sc1
    s_waitcnt vmcnt(0)
    s_branch A_P4_CHK
A_P4_OK:
    s_barrier
    buffer_load_dwordx4 v[8:11], v2, s[40:43], s64 offen offset:0 sc1
    buffer_load_dwordx4 v[12:15], v2, s[40:43], s64 offen offset:1024 sc1
    buffer_load_dwordx4 v[16:19], v2, s[40:43], s64 offen offset:2048 sc1
    buffer_load_dwordx4 v[20:23], v2, s[40:43], s64 offen offset:3072 sc1
    s_add_u32 s64, s64, 4096
    buffer_load_dwordx4 v[24:27], v2, s[40:43], s64 offen offset:0 sc1
    buffer_load_dwordx4 v[28:31], v2, s[40:43], s64 offen offset:1024 sc1
    buffer_load_dwordx4 v[32:35], v2, s[40:43], s64 offen offset:2048 sc1
    buffer_load_dwordx4 v[36:39], v2, s[40:43], s64 offen offset:3072 sc1
    s_add_u32 s64, s64, 4096
    buffer_load_dwordx4 v[40:43], v2, s[40:43], s64 offen offset:0 sc1
    buffer_load_dwordx4 v[44:47], v2, s[40:43], s64 offen offset:1024 sc1
    buffer_load_dwordx4 v[48:51], v2, s[40:43], s64 offen offset:2048 sc1
    buffer_load_dwordx4 v[52:55], v2, s[40:43], s64 offen offset:3072 sc1
    s_add_u32 s64, s64, 4096
    buffer_load_dwordx4 v[56:59], v2, s[40:43], s64 offen offset:0 sc1
    buffer_load_dwordx4 v[60:63], v2, s[40:43], s64 offen offset:1024 sc1
    buffer_load_dwordx4 v[64:67], v2, s[40:43], s64 offen offset:2048 sc1
    buffer_load_dwordx4 v[68:71], v2, s[40:43], s64 offen offset:3072 sc1
    s_add_u32 s64, s64, 4096
    s_waitcnt vmcnt(16)
    v_lshlrev_b32 v88, 16, v72
    v_and_b32 v89, 0xffff0000, v72
    v_lshlrev_b32 v90, 16, v73
    v_and_b32 v91, 0xffff0000, v73
    v_lshlrev_b32 v92, 16, v74
    v_and_b32 v93, 0xffff0000, v74
    v_lshlrev_b32 v94, 16, v75
    v_and_b32 v95, 0xffff0000, v75
    s_lshl_b32 s62, s48, 12
    s_add_u32 s62, s62, 131072
    v_add_u32 v240, s62, v2
    s_xor_b32 s62, s62, 0x4000
    v_add_u32 v241, s62, v2
    s_waitcnt vmcnt(15)
    v_mfma_f32_32x32x16_bf16 v[112:127], v[176:179], v[8:11], 0
    s_waitcnt vmcnt(14)
    v_mfma_f32_32x32x16_bf16 v[112:127], v[180:183], v[12:15], v[112:127]
    s_waitcnt vmcnt(13)
    v_mfma_f32_32x32x16_bf16 v[112:127], v[184:187], v[16:19], v[112:127]
    s_waitcnt vmcnt(12)
    v_mfma_f32_32x32x16_bf16 v[112:127], v[188:191], v[20:23], v[112:127]
    s_waitcnt vmcnt(11)
    v_mfma_f32_32x32x16_bf16 v[112:127], v[192:195], v[24:27], v[112:127]
    s_waitcnt vmcnt(10)
    v_mfma_f32_32x32x16_bf16 v[112:127], v[196:199], v[28:31], v[112:127]
    s_waitcnt vmcnt(9)
    v_mfma_f32_32x32x16_bf16 v[112:127], v[200:203], v[32:35], v[112:127]
    s_waitcnt vmcnt(8)
    v_mfma_f32_32x32x16_bf16 v[112:127], v[204:207], v[36:39], v[112:127]
    s_waitcnt vmcnt(7)
    v_mfma_f32_32x32x16_bf16 v[112:127], v[208:211], v[40:43], v[112:127]
    s_waitcnt vmcnt(6)
    v_mfma_f32_32x32x16_bf16 v[112:127], v[212:215], v[44:47], v[112:127]
    s_waitcnt vmcnt(5)
    v_mfma_f32_32x32x16_bf16 v[112:127], v[216:219], v[48:51], v[112:127]
    s_waitcnt vmcnt(4)
    v_mfma_f32_32x32x16_bf16 v[112:127], v[220:223], v[52:55], v[112:127]
    s_waitcnt vmcnt(3)
    v_mfma_f32_32x32x16_bf16 v[112:127], v[224:227], v[56:59], v[112:127]
    s_waitcnt vmcnt(2)
    v_mfma_f32_32x32x16_bf16 v[112:127], v[228:231], v[60:63], v[112:127]
    s_waitcnt vmcnt(1)
    v_mfma_f32_32x32x16_bf16 v[112:127], v[232:235], v[64:67], v[112:127]
    s_waitcnt vmcnt(0)
    v_mfma_f32_32x32x16_bf16 v[112:127], v[236:239], v[68:71], v[112:127]
    s_cmp_eq_u32 s53, 0
    s_nop 10
    s_cbranch_scc1 A_F0
    ds_write_b128 v240, v[112:115]
    ds_write_b128 v240, v[116:119] offset:1024
    s_nop 2
    v_mov_b32 v112, v120
    v_mov_b32 v113, v121
    v_mov_b32 v114, v122
    v_mov_b32 v115, v123
    v_mov_b32 v116, v124
    v_mov_b32 v117, v125
    v_mov_b32 v118, v126
    v_mov_b32 v119, v127
    s_branch A_F1
A_F0:
    ds_write_b128 v240, v[120:123]
    ds_write_b128 v240, v[124:127] offset:1024
A_F1:
    s_waitcnt lgkmcnt(0)
    s_barrier
    ds_read_b128 v[96:99], v241
    ds_read_b128 v[100:103], v241 offset:1024
    s_waitcnt lgkmcnt(0)
    v_add_f32 v112, v112, v96
    v_add_f32 v113, v113, v97
    v_add_f32 v114, v114, v98
    v_add_f32 v115, v115, v99
    v_add_f32 v116, v116, v100
    v_add_f32 v117, v117, v101
    v_add_f32 v118, v118, v102
    v_add_f32 v119, v119, v103
    v_fmac_f32 v88, v112, v80
    v_fmac_f32 v89, v113, v81
    v_fmac_f32 v90, v114, v82
    v_fmac_f32 v91, v115, v83
    v_fmac_f32 v92, v116, v84
    v_fmac_f32 v93, v117, v85
    v_fmac_f32 v94, v118, v86
    v_fmac_f32 v95, v119, v87
    v_cvt_pk_bf16_f32 v72, v88, v89
    v_cvt_pk_bf16_f32 v73, v90, v91
    v_cvt_pk_bf16_f32 v74, v92, v93
    v_cvt_pk_bf16_f32 v75, v94, v95
    buffer_store_dwordx2 v[72:73], v243, s[28:31], s67 offen
    buffer_store_dwordx2 v[74:75], v243, s[28:31], s67 offen offset:16
K1_EXIT:
    s_endpgm
K2_SLOW:
    v_mov_b32 v4, v2
    v_mov_b32 v5, v3
    v_mov_b32 v112, 0
    v_mov_b32 v113, 0
    v_mov_b32 v114, 0
    v_mov_b32 v115, 0
    v_mov_b32 v116, 0
    v_mov_b32 v117, 0
    v_mov_b32 v118, 0
    v_mov_b32 v119, 0
    v_mov_b32 v120, 0
    v_mov_b32 v121, 0
    v_mov_b32 v122, 0
    v_mov_b32 v123, 0
    v_mov_b32 v124, 0
    v_mov_b32 v125, 0
    v_mov_b32 v126, 0
    v_mov_b32 v127, 0
    v_mov_b32 v247, 0xff61b1e6
    s_mov_b32 s62, 64
K2_SLOOP:
    ds_read_b128 v[16:19], v4
    s_mov_b64 exec, s[60:61]
    ds_read_b128 v[24:27], v5
    ds_read_b128 v[28:31], v5 offset:512
    s_mov_b64 exec, -1
    s_waitcnt lgkmcnt(0)
    v_mfma_f32_32x32x16_bf16 v[80:95], v[16:19], v[8:11], 0
    s_nop 15
    v_max3_f32 v245, v80, v81, v82
    v_max3_f32 v245, v245, v83, v84
    v_max3_f32 v245, v245, v85, v86
    v_max3_f32 v245, v245, v87, v88
    v_max3_f32 v245, v245, v89, v90
    v_max3_f32 v245, v245, v91, v92
    v_max3_f32 v245, v245, v93, v94
    v_max3_f32 v245, v245, v95, v247
    v_mov_b32 v246, v245
    s_nop 1
    v_permlane32_swap_b32 v245, v246
    s_nop 1
    v_max_f32 v245, v245, v246
    v_sub_f32 v246, v247, v245
    v_exp_f32 v246, v246
    v_mov_b32 v247, v245
    v_mul_f32 v112, v246, v112
    v_mul_f32 v113, v246, v113
    v_mul_f32 v114, v246, v114
    v_mul_f32 v115, v246, v115
    v_mul_f32 v116, v246, v116
    v_mul_f32 v117, v246, v117
    v_mul_f32 v118, v246, v118
    v_mul_f32 v119, v246, v119
    v_mul_f32 v120, v246, v120
    v_mul_f32 v121, v246, v121
    v_mul_f32 v122, v246, v122
    v_mul_f32 v123, v246, v123
    v_mul_f32 v124, v246, v124
    v_mul_f32 v125, v246, v125
    v_mul_f32 v126, v246, v126
    v_mul_f32 v127, v246, v127
    v_sub_f32 v80, v80, v245
    v_exp_f32 v80, v80
    v_sub_f32 v81, v81, v245
    v_exp_f32 v81, v81
    v_sub_f32 v82, v82, v245
    v_exp_f32 v82, v82
    v_sub_f32 v83, v83, v245
    v_exp_f32 v83, v83
    v_sub_f32 v84, v84, v245
    v_exp_f32 v84, v84
    v_sub_f32 v85, v85, v245
    v_exp_f32 v85, v85
    v_sub_f32 v86, v86, v245
    v_exp_f32 v86, v86
    v_sub_f32 v87, v87, v245
    v_exp_f32 v87, v87
    v_sub_f32 v88, v88, v245
    v_exp_f32 v88, v88
    v_sub_f32 v89, v89, v245
    v_exp_f32 v89, v89
    v_sub_f32 v90, v90, v245
    v_exp_f32 v90, v90
    v_sub_f32 v91, v91, v245
    v_exp_f32 v91, v91
    v_sub_f32 v92, v92, v245
    v_exp_f32 v92, v92
    v_sub_f32 v93, v93, v245
    v_exp_f32 v93, v93
    v_sub_f32 v94, v94, v245
    v_exp_f32 v94, v94
    v_sub_f32 v95, v95, v245
    v_exp_f32 v95, v95
    s_nop 0
    v_cvt_pk_bf16_f32 v40, v80, v81
    v_cvt_pk_bf16_f32 v41, v82, v83
    v_cvt_pk_bf16_f32 v42, v84, v85
    v_cvt_pk_bf16_f32 v43, v86, v87
    v_cvt_pk_bf16_f32 v44, v88, v89
    v_cvt_pk_bf16_f32 v45, v90, v91
    v_cvt_pk_bf16_f32 v46, v92, v93
    v_cvt_pk_bf16_f32 v47, v94, v95
    s_nop 1
    v_mfma_f32_32x32x16_bf16 v[112:127], v[24:27], v[40:43], v[112:127]
    v_mfma_f32_32x32x16_bf16 v[112:127], v[28:31], v[44:47], v[112:127]
    s_sub_u32 s62, s62, 1
    s_and_b32 s37, s62, 7
    s_cmp_eq_u32 s37, 0
    s_cselect_b32 s37, 9, 1
    s_lshl_b32 s37, s37, 10
    v_add_u32 v4, s37, v4
    v_add_u32 v5, s37, v5
    s_nop 15
    s_cmp_lg_u32 s62, 0
    s_cbranch_scc1 K2_SLOOP
    s_branch K2_FIN
G_CODE_END:
.section .rodata,"a"
.p2align 6
.amdhsa_kernel recurrent_scan__mha_block__glu_gated_glu__prompt_kernel
  .amdhsa_next_free_vgpr 256
  .amdhsa_next_free_sgpr 102
  .amdhsa_accum_offset 256
  .amdhsa_group_segment_fixed_size 0
  .amdhsa_kernarg_size 80
  .amdhsa_user_sgpr_count 2
  .amdhsa_user_sgpr_kernarg_segment_ptr 1
  .amdhsa_system_sgpr_workgroup_id_x 1
.end_amdhsa_kernel
```
